```python
import torch

def _softmax(x, axis=-1):
    return torch.softmax(x, dim=axis)
def _gelu(x):
    return torch.nn.functional.gelu(x, approximate="tanh")
def _silu(x):
    return torch.nn.functional.silu(x)
def _sigmoid(x):
    return torch.sigmoid(x)
def _layernorm(x, axis=-1, eps=1e-5):
    m = x.mean(dim=axis, keepdim=True)
    v = x.var(dim=axis, keepdim=True, unbiased=False)
    return (x - m) / torch.sqrt(v + eps)
def _scatter_add(tgt, idx, src, axis=0):
    return tgt.clone().index_add_(axis, idx, src)
def _segment_sum(src, seg, n):
    out = torch.zeros((n,) + src.shape[1:], dtype=src.dtype)
    return out.index_add_(0, seg, src)
def _pad(x, pw):
    flat = tuple(v for pair in reversed(pw) for v in pair)
    return torch.nn.functional.pad(x, flat)

kernel_name = 'parallel_sum__ssm_conv_s4__dense_activation_mish__prompt'

def setup_inputs():

    _w = (lambda a: (lambda t: t.to(torch.bfloat16) if t.is_floating_point() else t)(torch.as_tensor(a)))
    def _A_setup():
        B, L, D, N = 1, 2048, 640, 192
        A_re = -(lambda _x: torch.exp(torch.as_tensor(_x)))((lambda *s: torch.randn(*s, dtype=torch.bfloat16) * 3.2)(D, N))
        A_im = torch.pi * (lambda *s: torch.randn(*s, dtype=torch.bfloat16) * 0.05)(D, N)
        B_re = (lambda *s: torch.randn(*s, dtype=torch.bfloat16) * 0.1)(D, N)
        B_im = (lambda *s: torch.randn(*s, dtype=torch.bfloat16) * 0.1)(D, N)
        C_re = (lambda *s: torch.randn(*s, dtype=torch.bfloat16) * 0.1)(D, N)
        C_im = (lambda *s: torch.randn(*s, dtype=torch.bfloat16) * 0.1)(D, N)
        log_dt = (lambda *s: torch.randn(*s, dtype=torch.bfloat16) * 0.05)(D) * 0.5 - 4.0
        Dskip = (lambda *s: torch.randn(*s, dtype=torch.bfloat16) * 0.05)(D)
        return {
            "u": _w((lambda *s: torch.randn(*s, dtype=torch.bfloat16) * 0.05)(B, L, D)),
            "A_re": _w(A_re),
            "A_im": _w(A_im),
            "B_re": _w(B_re),
            "B_im": _w(B_im),
            "C_re": _w(C_re),
            "C_im": _w(C_im),
            "log_dt": _w(log_dt),
            "Dskip": _w(Dskip),
        }
    _A_in = _A_setup()

    def _B_setup():
        B, S, D, F = 1, 2048, 640, 1536
        return {
            "x": _w((lambda *s: torch.randn(*s, dtype=torch.bfloat16) * 0.05)(B, S, D)),
            "w1": _w((lambda *s: torch.randn(*s, dtype=torch.bfloat16) * 0.8)(D, F) * (D ** -0.5)),
            "b1": _w((lambda *s: torch.randn(*s, dtype=torch.bfloat16) * 0.4)(F)),
            "w2": _w((lambda *s: torch.randn(*s, dtype=torch.bfloat16) * 0.2)(F, D) * (F ** -0.5)),
        }
    _B_in = _B_setup()

    return {
        "A_u": _A_in["u"],
        "A_A_re": _A_in["A_re"],
        "A_A_im": _A_in["A_im"],
        "A_B_re": _A_in["B_re"],
        "A_B_im": _A_in["B_im"],
        "A_C_re": _A_in["C_re"],
        "A_C_im": _A_in["C_im"],
        "A_log_dt": _A_in["log_dt"],
        "A_Dskip": _A_in["Dskip"],
        "B_x": _B_in["x"],
        "B_w1": _B_in["w1"],
        "B_b1": _B_in["b1"],
        "B_w2": _B_in["w2"],
    }

def reference(A_u, A_A_re, A_A_im, A_B_re, A_B_im, A_C_re, A_C_im, A_log_dt, A_Dskip, B_x, B_w1, B_b1, B_w2):
    def _A_ref(u, A_re, A_im, B_re, B_im, C_re, C_im, log_dt, Dskip):
        Bsz, L, D = u.shape
        dt = torch.exp(log_dt)[:, None]
        A = A_re + 1j * A_im
        Bc = B_re + 1j * B_im
        Cc = C_re + 1j * C_im
        logdA = dt * A
        dB = dt * Bc
        l = (lambda x, dt: x.to(dt))(torch.arange(L), A_re.dtype)
        P = torch.exp(logdA[:, :, None] * l[None, None, :])
        K = torch.einsum("dn,dnl,dn->dl", Cc, P, dB).real
        L2 = 2 * L
        Kp = _pad(K, ((0, 0), (0, L)))
        up = (lambda x, *d: x.permute(*d))(u, 0, 2, 1)
        up = _pad(up, ((0, 0), (0, 0), (0, L)))
        Kf = (lambda x, axes=(-2,-1): torch.fft.rfft2(x.float(), dim=axes))(Kp[:, None, :], axes=(-2, -1))
        Uf = (lambda x, axes=(-2,-1): torch.fft.rfft2(x.float(), dim=axes))(up[:, :, None, :], axes=(-2, -1))
        Yf = Uf * Kf[None, :, :, :]
        y = (lambda x, s, axes=(-2,-1): torch.fft.irfft2(x, s=s, dim=axes).to(torch.bfloat16))(Yf, (1, L2), axes=(-2, -1))[:, :, 0, :L]
        y = (lambda x, *d: x.permute(*d))(y, 0, 2, 1) + u * Dskip[None, None, :]
        return y

    def _B_ref(x, w1, b1, w2):
        h = torch.einsum("bsd,df->bsf", x, w1) + b1
        sp = torch.log1p(torch.exp(-torch.abs(h))) + torch.where(h > 0, h, torch.zeros_like(h))
        act = h * torch.tanh(sp)
        return torch.einsum("bsf,fd->bsd", act, w2)

    x = A_u
    xn = _layernorm(x, axis=-1)
    return x + _A_ref(xn, A_A_re, A_A_im, A_B_re, A_B_im, A_C_re, A_C_im, A_log_dt, A_Dskip) + _B_ref(xn, B_w1, B_b1, B_w2)
```

```asm
; @launch grid=(512,1,1) block=(256,1,1) lds=81920
.amdgcn_target "amdgcn-amd-amdhsa--gfx950"
.text
.globl parallel_sum__ssm_conv_s4__dense_activation_mish__prompt_kernel
.p2align 8
.type parallel_sum__ssm_conv_s4__dense_activation_mish__prompt_kernel,@function
parallel_sum__ssm_conv_s4__dense_activation_mish__prompt_kernel:
  s_cmp_ge_u32 s2, 512
  s_cbranch_scc1 Lend
  s_load_dwordx16 s[16:31], s[0:1], 0
  s_load_dwordx16 s[32:47], s[0:1], 64
  v_lshrrev_b32 v1, 6, v0
  v_and_b32 v0, 63, v0
  v_readfirstlane_b32 s3, v1
  s_waitcnt lgkmcnt(0)
  s_load_dword s53, s[46:47], 0
  s_mov_b32 s4, s16
  s_mov_b32 s5, s17
  s_mov_b32 s6, 2621440
  s_mov_b32 s7, 0x20000
  s_mov_b32 s8, s36
  s_mov_b32 s9, s37
  s_mov_b32 s10, 1966080
  s_mov_b32 s11, 0x20000
  s_mov_b32 s12, s46
  s_mov_b32 s13, s47
  s_mov_b32 s14, 17301504
  s_mov_b32 s15, 0x20000
  s_cmp_lt_u32 s2, 256
  s_cbranch_scc1 Lssm
  s_setprio 2
  s_and_b32 s68, s2, 7
  s_lshr_b32 s69, s2, 3
  s_and_b32 s69, s69, 31
  s_lshr_b32 s54, s68, 1
  s_lshl_b32 s54, s54, 3
  s_and_b32 s70, s69, 7
  s_add_u32 s54, s54, s70
  s_and_b32 s55, s68, 1
  s_lshl_b32 s55, s55, 2
  s_lshr_b32 s70, s69, 3
  s_add_u32 s55, s55, s70
  s_lshl_b32 s58, s3, 11
  v_lshrrev_b32 v22, 3, v0
  s_lshl_b32 s70, s3, 4
  v_add_u32 v22, s70, v22
  v_lshrrev_b32 v23, 4, v0
  v_and_b32 v24, 7, v0
  v_xor_b32 v25, v24, v23
  s_lshl_b32 s71, s54, 6
  v_add_u32 v26, s71, v22
  v_mul_u32_u24 v26, 0x500, v26
  v_lshl_add_u32 v1, v25, 4, v26
  v_xor_b32 v25, 4, v25
  v_lshl_add_u32 v2, v25, 4, v26
  v_add_u32 v2, 9216, v2
  v_and_b32 v23, 1, v23
  v_lshlrev_b32 v23, 2, v23
  v_xor_b32 v25, v24, v23
  v_mul_u32_u24 v26, 0xc00, v22
  v_lshl_add_u32 v3, v25, 4, v26
  s_mul_i32 s70, s55, 384
  v_add_u32 v3, s70, v3
  v_add_u32 v4, 23552, v3
  s_and_b32 s70, s54, 7
  s_and_b32 s71, s55, 3
  s_mul_i32 s71, s71, 0
  s_mul_i32 s70, s70, 0
  s_add_u32 s70, s70, s71
  s_cmp_ge_u32 s70, 10
  s_cselect_b32 s71, 10, 0
  s_sub_u32 s70, s70, s71
  s_lshl_b32 s16, s70, 7
  s_mul_i32 s26, s70, 196608
  s_add_u32 s70, s70, 1
  s_cmp_eq_u32 s70, 10
  s_cselect_b32 s70, 0, s70
  s_lshl_b32 s17, s70, 7
  s_mul_i32 s27, s70, 196608
  s_add_u32 s70, s70, 1
  s_cmp_eq_u32 s70, 10
  s_cselect_b32 s70, 0, s70
  s_lshl_b32 s18, s70, 7
  s_mul_i32 s28, s70, 196608
  s_add_u32 s70, s70, 1
  s_cmp_eq_u32 s70, 10
  s_cselect_b32 s70, 0, s70
  s_lshl_b32 s19, s70, 7
  s_mul_i32 s29, s70, 196608
  s_add_u32 s70, s70, 1
  s_cmp_eq_u32 s70, 10
  s_cselect_b32 s70, 0, s70
  s_lshl_b32 s20, s70, 7
  s_mul_i32 s30, s70, 196608
  s_add_u32 s70, s70, 1
  s_cmp_eq_u32 s70, 10
  s_cselect_b32 s70, 0, s70
  s_lshl_b32 s21, s70, 7
  s_mul_i32 s31, s70, 196608
  s_add_u32 s70, s70, 1
  s_cmp_eq_u32 s70, 10
  s_cselect_b32 s70, 0, s70
  s_lshl_b32 s22, s70, 7
  s_mul_i32 s32, s70, 196608
  s_add_u32 s70, s70, 1
  s_cmp_eq_u32 s70, 10
  s_cselect_b32 s70, 0, s70
  s_lshl_b32 s23, s70, 7
  s_mul_i32 s33, s70, 196608
  s_add_u32 s70, s70, 1
  s_cmp_eq_u32 s70, 10
  s_cselect_b32 s70, 0, s70
  s_lshl_b32 s24, s70, 7
  s_mul_i32 s34, s70, 196608
  s_add_u32 s70, s70, 1
  s_cmp_eq_u32 s70, 10
  s_cselect_b32 s70, 0, s70
  s_lshl_b32 s25, s70, 7
  s_mul_i32 s35, s70, 196608
  s_add_u32 m0, s58, 0
  s_nop 0
  buffer_load_dwordx4 v1, s[4:7], s16 offen lds
  buffer_load_dwordx4 v2, s[4:7], s16 offen offset:1024 lds
  s_add_u32 m0, s58, 8192
  s_nop 0
  buffer_load_dwordx4 v3, s[8:11], s26 offen lds
  buffer_load_dwordx4 v4, s[8:11], s26 offen offset:1024 lds
  s_add_u32 m0, s58, 16384
  s_nop 0
  buffer_load_dwordx4 v1, s[4:7], s17 offen lds
  buffer_load_dwordx4 v2, s[4:7], s17 offen offset:1024 lds
  s_add_u32 m0, s58, 24576
  s_nop 0
  buffer_load_dwordx4 v3, s[8:11], s27 offen lds
  buffer_load_dwordx4 v4, s[8:11], s27 offen offset:1024 lds
  s_add_u32 m0, s58, 32768
  s_nop 0
  buffer_load_dwordx4 v1, s[4:7], s18 offen lds
  buffer_load_dwordx4 v2, s[4:7], s18 offen offset:1024 lds
  s_add_u32 m0, s58, 40960
  s_nop 0
  buffer_load_dwordx4 v3, s[8:11], s28 offen lds
  buffer_load_dwordx4 v4, s[8:11], s28 offen offset:1024 lds
  s_add_u32 m0, s58, 49152
  s_nop 0
  buffer_load_dwordx4 v1, s[4:7], s19 offen lds
  buffer_load_dwordx4 v2, s[4:7], s19 offen offset:1024 lds
  s_add_u32 m0, s58, 57344
  s_nop 0
  buffer_load_dwordx4 v3, s[8:11], s29 offen lds
  buffer_load_dwordx4 v4, s[8:11], s29 offen offset:1024 lds
  s_add_u32 m0, s58, 65536
  s_nop 0
  buffer_load_dwordx4 v1, s[4:7], s20 offen lds
  buffer_load_dwordx4 v2, s[4:7], s20 offen offset:1024 lds
  s_add_u32 m0, s58, 73728
  s_nop 0
  buffer_load_dwordx4 v3, s[8:11], s30 offen lds
  buffer_load_dwordx4 v4, s[8:11], s30 offen offset:1024 lds
  s_mov_b32 s48, s42
  s_mov_b32 s49, s43
  s_mov_b32 s50, 2621440
  s_mov_b32 s51, 0x20000
  s_and_b32 s56, s3, 1
  s_lshr_b32 s57, s3, 1
  v_and_b32 v22, 31, v0
  v_lshrrev_b32 v23, 5, v0
  v_lshrrev_b32 v24, 1, v22
  v_and_b32 v24, 7, v24
  s_lshl_b32 s70, s56, 12
  v_lshl_add_u32 v25, v22, 7, s70
  v_add_u32 v26, 0, v23
  v_xor_b32 v26, v26, v24
  v_lshl_add_u32 v5, v26, 4, v25
  v_add_u32 v26, 2, v23
  v_xor_b32 v26, v26, v24
  v_lshl_add_u32 v6, v26, 4, v25
  v_add_u32 v26, 4, v23
  v_xor_b32 v26, v26, v24
  v_lshl_add_u32 v7, v26, 4, v25
  v_add_u32 v26, 6, v23
  v_xor_b32 v26, v26, v24
  v_lshl_add_u32 v8, v26, 4, v25
  v_lshrrev_b32 v26, 4, v22
  s_lshl_b32 s70, s56, 1
  v_add_u32 v26, s70, v26
  v_mul_u32_u24 v26, 0xc000, v26
  v_lshl_add_u32 v26, v23, 8, v26
  v_and_b32 v27, 15, v0
  v_lshl_add_u32 v11, v27, 4, v26
  v_lshrrev_b32 v24, 2, v27
  v_and_b32 v25, 3, v0
  v_lshrrev_b32 v26, 4, v0
  v_and_b32 v26, 1, v26
  v_lshlrev_b32 v26, 1, v26
  v_lshrrev_b32 v28, 1, v25
  v_add_u32 v26, v26, v28
  s_lshl_b32 s70, s57, 2
  v_add_u32 v26, s70, v26
  v_lshrrev_b32 v28, 1, v24
  v_lshlrev_b32 v28, 2, v28
  v_xor_b32 v26, v26, v28
  v_lshl_add_u32 v28, v23, 3, v24
  v_lshlrev_b32 v28, 7, v28
  v_lshl_add_u32 v28, v26, 4, v28
  v_and_b32 v25, 1, v25
  v_lshl_add_u32 v9, v25, 3, v28
  v_add_u32 v10, 0x10000, v9
  v_add_u32 v15, -1, v23
  s_mul_i32 s61, s54, 192
  s_mul_i32 s70, s55, 6
  s_add_u32 s61, s61, s70
  s_add_u32 s61, s61, s57
  s_lshl_b32 s61, s61, 10
  s_add_u32 s61, s61, 10485760
  s_mul_i32 s81, s54, 12288
  s_lshl_b32 s71, s55, 9
  s_add_u32 s81, s81, s71
  s_lshl_b32 s71, s3, 7
  s_add_u32 s81, s81, s71
  s_add_u32 s81, s81, 16777216
  v_mov_b32 v16, 0
  v_mov_b32 v17, 0
  v_add_u32 v24, -8, v0
  v_lshrrev_b32 v25, 2, v24
  v_and_b32 v24, 3, v24
  s_and_b32 s70, s55, 3
  s_mul_i32 s70, s70, 3
  v_add_u32 v25, s70, v25
  v_lshlrev_b32 v25, 3, v25
  v_lshl_add_u32 v25, v24, 1, v25
  s_lshr_b32 s70, s55, 2
  v_add_u32 v25, s70, v25
  v_and_b32 v24, 7, v0
  s_and_b32 s70, s54, 3
  s_lshl_b32 s70, s70, 6
  s_lshr_b32 s71, s54, 2
  s_add_u32 s70, s70, s71
  v_lshl_add_u32 v24, v24, 3, s70
  v_add_u32 v26, -8, v0
  v_cmp_gt_u32 vcc, 12, v26
  s_nop 1
  v_cndmask_b32 v24, v24, v25, vcc
  v_lshlrev_b32 v34, 7, v24
  s_mul_i32 s70, s55, 192
  s_lshl_b32 s71, s57, 5
  s_add_u32 s70, s70, s71
  v_add_u32 v24, s70, v22
  v_lshlrev_b32 v35, 2, v24
  v_lshlrev_b32 v39, 1, v24
  v_mul_u32_u24 v25, 6144, v23
  v_add_u32 v35, v35, v25
  v_lshl_add_u32 v36, v23, 7, v39
  s_lshl_b32 s70, s54, 6
  s_lshl_b32 s71, s56, 5
  s_add_u32 s70, s70, s71
  v_add_u32 v24, s70, v22
  v_lshlrev_b32 v37, 2, v24
  s_waitcnt lgkmcnt(0)
  s_mul_i32 s52, s53, 0x9E3779B1
  s_add_u32 s52, s52, 0x7F4A7C15
  s_waitcnt vmcnt(16)
  s_barrier
  ds_read_b64_tr_b16 v[40:41], v9 offset:8192
  ds_read_b64_tr_b16 v[42:43], v9 offset:8704
  ds_read_b128 v[96:99], v5 offset:0
  ds_read_b64_tr_b16 v[44:45], v9 offset:10240
  ds_read_b64_tr_b16 v[46:47], v9 offset:10752
  ds_read_b128 v[100:103], v6 offset:0
  ds_read_b64_tr_b16 v[48:49], v9 offset:12288
  ds_read_b64_tr_b16 v[50:51], v9 offset:12800
  ds_read_b128 v[104:107], v7 offset:0
  ds_read_b64_tr_b16 v[52:53], v9 offset:14336
  ds_read_b64_tr_b16 v[54:55], v9 offset:14848
  ds_read_b128 v[108:111], v8 offset:0
  s_waitcnt vmcnt(12)
  s_barrier
  ds_read_b64_tr_b16 v[56:57], v9 offset:24576
  ds_read_b64_tr_b16 v[58:59], v9 offset:25088
  ds_read_b128 v[112:115], v5 offset:16384
  ds_read_b64_tr_b16 v[60:61], v9 offset:26624
  ds_read_b64_tr_b16 v[62:63], v9 offset:27136
  ds_read_b128 v[116:119], v6 offset:16384
  s_waitcnt lgkmcnt(6)
  v_mfma_f32_32x32x16_bf16 v[80:95], v[40:43], v[96:99], 0
  v_mfma_f32_32x32x16_bf16 v[80:95], v[44:47], v[100:103], v[80:95]
  ds_read_b64_tr_b16 v[40:41], v9 offset:28672
  ds_read_b64_tr_b16 v[42:43], v9 offset:29184
  ds_read_b128 v[120:123], v7 offset:16384
  ds_read_b64_tr_b16 v[44:45], v9 offset:30720
  ds_read_b64_tr_b16 v[46:47], v9 offset:31232
  ds_read_b128 v[124:127], v8 offset:16384
  v_mfma_f32_32x32x16_bf16 v[80:95], v[48:51], v[104:107], v[80:95]
  v_mfma_f32_32x32x16_bf16 v[80:95], v[52:55], v[108:111], v[80:95]
  s_waitcnt vmcnt(8)
  s_barrier
  ds_read_b64_tr_b16 v[48:49], v9 offset:40960
  ds_read_b64_tr_b16 v[50:51], v9 offset:41472
  ds_read_b128 v[128:131], v5 offset:32768
  ds_read_b64_tr_b16 v[52:53], v9 offset:43008
  ds_read_b64_tr_b16 v[54:55], v9 offset:43520
  ds_read_b128 v[132:135], v6 offset:32768
  s_waitcnt lgkmcnt(6)
  v_mfma_f32_32x32x16_bf16 v[80:95], v[56:59], v[112:115], v[80:95]
  s_add_u32 m0, s58, 0
  s_nop 0
  buffer_load_dwordx4 v1, s[4:7], s21 offen lds
  v_mfma_f32_32x32x16_bf16 v[80:95], v[60:63], v[116:119], v[80:95]
  ds_read_b64_tr_b16 v[56:57], v9 offset:45056
  ds_read_b64_tr_b16 v[58:59], v9 offset:45568
  ds_read_b128 v[136:139], v7 offset:32768
  ds_read_b64_tr_b16 v[60:61], v9 offset:47104
  ds_read_b64_tr_b16 v[62:63], v9 offset:47616
  ds_read_b128 v[140:143], v8 offset:32768
  buffer_load_dwordx4 v2, s[4:7], s21 offen offset:1024 lds
  v_mfma_f32_32x32x16_bf16 v[80:95], v[40:43], v[120:123], v[80:95]
  s_add_u32 m0, s58, 8192
  s_nop 0
  buffer_load_dwordx4 v3, s[8:11], s31 offen lds
  v_mfma_f32_32x32x16_bf16 v[80:95], v[44:47], v[124:127], v[80:95]
  buffer_load_dwordx4 v4, s[8:11], s31 offen offset:1024 lds
  s_waitcnt vmcnt(8)
  s_barrier
  ds_read_b64_tr_b16 v[40:41], v9 offset:57344
  ds_read_b64_tr_b16 v[42:43], v9 offset:57856
  ds_read_b128 v[144:147], v5 offset:49152
  ds_read_b64_tr_b16 v[44:45], v9 offset:59392
  ds_read_b64_tr_b16 v[46:47], v9 offset:59904
  ds_read_b128 v[148:151], v6 offset:49152
  s_waitcnt lgkmcnt(6)
  v_mfma_f32_32x32x16_bf16 v[80:95], v[48:51], v[128:131], v[80:95]
  s_add_u32 m0, s58, 16384
  s_nop 0
  buffer_load_dwordx4 v1, s[4:7], s22 offen lds
  v_mfma_f32_32x32x16_bf16 v[80:95], v[52:55], v[132:135], v[80:95]
  ds_read_b64_tr_b16 v[48:49], v9 offset:61440
  ds_read_b64_tr_b16 v[50:51], v9 offset:61952
  ds_read_b128 v[152:155], v7 offset:49152
  ds_read_b64_tr_b16 v[52:53], v9 offset:63488
  ds_read_b64_tr_b16 v[54:55], v9 offset:64000
  ds_read_b128 v[156:159], v8 offset:49152
  buffer_load_dwordx4 v2, s[4:7], s22 offen offset:1024 lds
  v_mfma_f32_32x32x16_bf16 v[80:95], v[56:59], v[136:139], v[80:95]
  s_add_u32 m0, s58, 24576
  s_nop 0
  buffer_load_dwordx4 v3, s[8:11], s32 offen lds
  v_mfma_f32_32x32x16_bf16 v[80:95], v[60:63], v[140:143], v[80:95]
  buffer_load_dwordx4 v4, s[8:11], s32 offen offset:1024 lds
  s_waitcnt vmcnt(8)
  s_barrier
  v_add_u32 v5, 0x10000, v5
  v_add_u32 v6, 0x10000, v6
  v_add_u32 v7, 0x10000, v7
  v_add_u32 v8, 0x10000, v8
  ds_read_b64_tr_b16 v[56:57], v10 offset:8192
  ds_read_b64_tr_b16 v[58:59], v10 offset:8704
  ds_read_b128 v[160:163], v5 offset:0
  ds_read_b64_tr_b16 v[60:61], v10 offset:10240
  ds_read_b64_tr_b16 v[62:63], v10 offset:10752
  ds_read_b128 v[164:167], v6 offset:0
  s_waitcnt lgkmcnt(6)
  v_mfma_f32_32x32x16_bf16 v[80:95], v[40:43], v[144:147], v[80:95]
  s_add_u32 m0, s58, 32768
  s_nop 0
  buffer_load_dwordx4 v1, s[4:7], s23 offen lds
  v_mfma_f32_32x32x16_bf16 v[80:95], v[44:47], v[148:151], v[80:95]
  ds_read_b64_tr_b16 v[40:41], v10 offset:12288
  ds_read_b64_tr_b16 v[42:43], v10 offset:12800
  ds_read_b128 v[168:171], v7 offset:0
  ds_read_b64_tr_b16 v[44:45], v10 offset:14336
  ds_read_b64_tr_b16 v[46:47], v10 offset:14848
  ds_read_b128 v[172:175], v8 offset:0
  buffer_load_dwordx4 v2, s[4:7], s23 offen offset:1024 lds
  v_add_u32 v5, 0xffff0000, v5
  v_add_u32 v6, 0xffff0000, v6
  v_add_u32 v7, 0xffff0000, v7
  v_add_u32 v8, 0xffff0000, v8
  v_mfma_f32_32x32x16_bf16 v[80:95], v[48:51], v[152:155], v[80:95]
  s_add_u32 m0, s58, 40960
  s_nop 0
  buffer_load_dwordx4 v3, s[8:11], s33 offen lds
  v_mfma_f32_32x32x16_bf16 v[80:95], v[52:55], v[156:159], v[80:95]
  buffer_load_dwordx4 v4, s[8:11], s33 offen offset:1024 lds
  s_waitcnt vmcnt(8)
  s_barrier
  ds_read_b64_tr_b16 v[48:49], v9 offset:8192
  ds_read_b64_tr_b16 v[50:51], v9 offset:8704
  ds_read_b128 v[176:179], v5 offset:0
  ds_read_b64_tr_b16 v[52:53], v9 offset:10240
  ds_read_b64_tr_b16 v[54:55], v9 offset:10752
  ds_read_b128 v[180:183], v6 offset:0
  s_waitcnt lgkmcnt(6)
  v_mfma_f32_32x32x16_bf16 v[80:95], v[56:59], v[160:163], v[80:95]
  s_add_u32 m0, s58, 49152
  s_nop 0
  buffer_load_dwordx4 v1, s[4:7], s24 offen lds
  v_mfma_f32_32x32x16_bf16 v[80:95], v[60:63], v[164:167], v[80:95]
  ds_read_b64_tr_b16 v[56:57], v9 offset:12288
  ds_read_b64_tr_b16 v[58:59], v9 offset:12800
  ds_read_b128 v[184:187], v7 offset:0
  ds_read_b64_tr_b16 v[60:61], v9 offset:14336
  ds_read_b64_tr_b16 v[62:63], v9 offset:14848
  ds_read_b128 v[188:191], v8 offset:0
  buffer_load_dwordx4 v2, s[4:7], s24 offen offset:1024 lds
  v_mfma_f32_32x32x16_bf16 v[80:95], v[40:43], v[168:171], v[80:95]
  s_add_u32 m0, s58, 57344
  s_nop 0
  buffer_load_dwordx4 v3, s[8:11], s34 offen lds
  v_mfma_f32_32x32x16_bf16 v[80:95], v[44:47], v[172:175], v[80:95]
  buffer_load_dwordx4 v4, s[8:11], s34 offen offset:1024 lds
  s_waitcnt vmcnt(8)
  s_barrier
  ds_read_b64_tr_b16 v[40:41], v9 offset:24576
  ds_read_b64_tr_b16 v[42:43], v9 offset:25088
  ds_read_b128 v[192:195], v5 offset:16384
  ds_read_b64_tr_b16 v[44:45], v9 offset:26624
  ds_read_b64_tr_b16 v[46:47], v9 offset:27136
  ds_read_b128 v[196:199], v6 offset:16384
  s_waitcnt lgkmcnt(6)
  v_mfma_f32_32x32x16_bf16 v[80:95], v[48:51], v[176:179], v[80:95]
  s_add_u32 m0, s58, 65536
  s_nop 0
  buffer_load_dwordx4 v1, s[4:7], s25 offen lds
  v_mfma_f32_32x32x16_bf16 v[80:95], v[52:55], v[180:183], v[80:95]
  ds_read_b64_tr_b16 v[48:49], v9 offset:28672
  ds_read_b64_tr_b16 v[50:51], v9 offset:29184
  ds_read_b128 v[200:203], v7 offset:16384
  ds_read_b64_tr_b16 v[52:53], v9 offset:30720
  ds_read_b64_tr_b16 v[54:55], v9 offset:31232
  ds_read_b128 v[204:207], v8 offset:16384
  buffer_load_dwordx4 v2, s[4:7], s25 offen offset:1024 lds
  v_mfma_f32_32x32x16_bf16 v[80:95], v[56:59], v[184:187], v[80:95]
  s_add_u32 m0, s58, 73728
  s_nop 0
  buffer_load_dwordx4 v3, s[8:11], s35 offen lds
  v_mfma_f32_32x32x16_bf16 v[80:95], v[60:63], v[188:191], v[80:95]
  buffer_load_dwordx4 v4, s[8:11], s35 offen offset:1024 lds
  s_waitcnt vmcnt(8)
  s_barrier
  ds_read_b64_tr_b16 v[56:57], v9 offset:40960
  ds_read_b64_tr_b16 v[58:59], v9 offset:41472
  ds_read_b128 v[208:211], v5 offset:32768
  ds_read_b64_tr_b16 v[60:61], v9 offset:43008
  ds_read_b64_tr_b16 v[62:63], v9 offset:43520
  ds_read_b128 v[212:215], v6 offset:32768
  s_waitcnt lgkmcnt(6)
  v_mfma_f32_32x32x16_bf16 v[80:95], v[40:43], v[192:195], v[80:95]
  s_add_u32 m0, s58, 0
  v_add_u32 v3, 128, v3
  v_add_u32 v4, 128, v4
  buffer_load_dwordx4 v3, s[8:11], s26 offen lds
  v_mfma_f32_32x32x16_bf16 v[80:95], v[44:47], v[196:199], v[80:95]
  ds_read_b64_tr_b16 v[40:41], v9 offset:45056
  ds_read_b64_tr_b16 v[42:43], v9 offset:45568
  ds_read_b128 v[216:219], v7 offset:32768
  ds_read_b64_tr_b16 v[44:45], v9 offset:47104
  ds_read_b64_tr_b16 v[46:47], v9 offset:47616
  ds_read_b128 v[220:223], v8 offset:32768
  buffer_load_dwordx4 v4, s[8:11], s26 offen offset:1024 lds
  v_mfma_f32_32x32x16_bf16 v[80:95], v[48:51], v[200:203], v[80:95]
  s_add_u32 m0, s58, 8192
  s_nop 0
  buffer_load_dwordx4 v3, s[8:11], s27 offen lds
  v_mfma_f32_32x32x16_bf16 v[80:95], v[52:55], v[204:207], v[80:95]
  buffer_load_dwordx4 v4, s[8:11], s27 offen offset:1024 lds
  s_waitcnt vmcnt(8)
  s_barrier
  ds_read_b64_tr_b16 v[48:49], v9 offset:57344
  ds_read_b64_tr_b16 v[50:51], v9 offset:57856
  ds_read_b128 v[224:227], v5 offset:49152
  ds_read_b64_tr_b16 v[52:53], v9 offset:59392
  ds_read_b64_tr_b16 v[54:55], v9 offset:59904
  ds_read_b128 v[228:231], v6 offset:49152
  s_waitcnt lgkmcnt(6)
  v_mfma_f32_32x32x16_bf16 v[80:95], v[56:59], v[208:211], v[80:95]
  s_add_u32 m0, s58, 16384
  s_nop 0
  buffer_load_dwordx4 v3, s[8:11], s28 offen lds
  v_mfma_f32_32x32x16_bf16 v[80:95], v[60:63], v[212:215], v[80:95]
  ds_read_b64_tr_b16 v[56:57], v9 offset:61440
  ds_read_b64_tr_b16 v[58:59], v9 offset:61952
  ds_read_b128 v[232:235], v7 offset:49152
  ds_read_b64_tr_b16 v[60:61], v9 offset:63488
  ds_read_b64_tr_b16 v[62:63], v9 offset:64000
  ds_read_b128 v[236:239], v8 offset:49152
  buffer_load_dwordx4 v4, s[8:11], s28 offen offset:1024 lds
  v_mfma_f32_32x32x16_bf16 v[80:95], v[40:43], v[216:219], v[80:95]
  s_add_u32 m0, s58, 24576
  s_nop 0
  buffer_load_dwordx4 v3, s[8:11], s29 offen lds
  v_mfma_f32_32x32x16_bf16 v[80:95], v[44:47], v[220:223], v[80:95]
  buffer_load_dwordx4 v4, s[8:11], s29 offen offset:1024 lds
  s_waitcnt vmcnt(8)
  s_barrier
  v_add_u32 v5, 0x10000, v5
  v_add_u32 v6, 0x10000, v6
  v_add_u32 v7, 0x10000, v7
  v_add_u32 v8, 0x10000, v8
  ds_read_b64_tr_b16 v[40:41], v10 offset:8192
  ds_read_b64_tr_b16 v[42:43], v10 offset:8704
  ds_read_b128 v[240:243], v5 offset:0
  ds_read_b64_tr_b16 v[44:45], v10 offset:10240
  ds_read_b64_tr_b16 v[46:47], v10 offset:10752
  ds_read_b128 v[244:247], v6 offset:0
  s_waitcnt lgkmcnt(6)
  v_mfma_f32_32x32x16_bf16 v[80:95], v[48:51], v[224:227], v[80:95]
  s_add_u32 m0, s58, 32768
  s_nop 0
  buffer_load_dwordx4 v3, s[8:11], s30 offen lds
  v_mfma_f32_32x32x16_bf16 v[80:95], v[52:55], v[228:231], v[80:95]
  ds_read_b64_tr_b16 v[48:49], v10 offset:12288
  ds_read_b64_tr_b16 v[50:51], v10 offset:12800
  ds_read_b128 v[248:251], v7 offset:0
  ds_read_b64_tr_b16 v[52:53], v10 offset:14336
  ds_read_b64_tr_b16 v[54:55], v10 offset:14848
  ds_read_b128 v[252:255], v8 offset:0
  buffer_load_dwordx4 v4, s[8:11], s30 offen offset:1024 lds
  v_add_u32 v5, 0xffff0000, v5
  v_add_u32 v6, 0xffff0000, v6
  v_add_u32 v7, 0xffff0000, v7
  v_add_u32 v8, 0xffff0000, v8
  v_mfma_f32_32x32x16_bf16 v[80:95], v[56:59], v[232:235], v[80:95]
  s_add_u32 m0, s58, 40960
  s_nop 0
  buffer_load_dwordx4 v3, s[8:11], s31 offen lds
  v_mfma_f32_32x32x16_bf16 v[80:95], v[60:63], v[236:239], v[80:95]
  buffer_load_dwordx4 v4, s[8:11], s31 offen offset:1024 lds
  s_waitcnt vmcnt(10)
  s_barrier
  ds_read_b64_tr_b16 v[56:57], v9 offset:0
  ds_read_b64_tr_b16 v[58:59], v9 offset:512
  ds_read_b64_tr_b16 v[60:61], v9 offset:2048
  ds_read_b64_tr_b16 v[62:63], v9 offset:2560
  s_waitcnt lgkmcnt(4)
  v_mfma_f32_32x32x16_bf16 v[80:95], v[40:43], v[240:243], v[80:95]
  s_add_u32 m0, s58, 49152
  s_nop 0
  buffer_load_dwordx4 v3, s[8:11], s32 offen lds
  v_mfma_f32_32x32x16_bf16 v[80:95], v[44:47], v[244:247], v[80:95]
  ds_read_b64_tr_b16 v[40:41], v9 offset:4096
  ds_read_b64_tr_b16 v[42:43], v9 offset:4608
  ds_read_b64_tr_b16 v[44:45], v9 offset:6144
  ds_read_b64_tr_b16 v[46:47], v9 offset:6656
  buffer_load_dwordx4 v4, s[8:11], s32 offen offset:1024 lds
  v_mfma_f32_32x32x16_bf16 v[80:95], v[48:51], v[248:251], v[80:95]
  s_add_u32 m0, s58, 57344
  s_nop 0
  buffer_load_dwordx4 v3, s[8:11], s33 offen lds
  v_mfma_f32_32x32x16_bf16 v[80:95], v[52:55], v[252:255], v[80:95]
  buffer_load_dwordx4 v4, s[8:11], s33 offen offset:1024 lds
  s_setprio 2
  s_waitcnt vmcnt(12)
  s_barrier
  ds_read_b64_tr_b16 v[48:49], v9 offset:8192
  ds_read_b64_tr_b16 v[50:51], v9 offset:8704
  ds_read_b64_tr_b16 v[52:53], v9 offset:10240
  ds_read_b64_tr_b16 v[54:55], v9 offset:10752
  s_waitcnt lgkmcnt(4)
  v_mfma_f32_32x32x16_bf16 v[64:79], v[56:59], v[96:99], 0
  s_add_u32 m0, s58, 65536
  s_nop 0
  buffer_load_dwordx4 v3, s[8:11], s34 offen lds
  v_mfma_f32_32x32x16_bf16 v[64:79], v[60:63], v[100:103], v[64:79]
  ds_read_b64_tr_b16 v[56:57], v9 offset:12288
  ds_read_b64_tr_b16 v[58:59], v9 offset:12800
  ds_read_b64_tr_b16 v[60:61], v9 offset:14336
  ds_read_b64_tr_b16 v[62:63], v9 offset:14848
  buffer_load_dwordx4 v4, s[8:11], s34 offen offset:1024 lds
  v_mfma_f32_32x32x16_bf16 v[64:79], v[40:43], v[104:107], v[64:79]
  s_add_u32 m0, s58, 73728
  s_nop 0
  buffer_load_dwordx4 v3, s[8:11], s35 offen lds
  v_mfma_f32_32x32x16_bf16 v[64:79], v[44:47], v[108:111], v[64:79]
  buffer_load_dwordx4 v4, s[8:11], s35 offen offset:1024 lds
  s_mov_b32 s75, 32768
  s_cmp_lg_u32 s3, 0
  s_cbranch_scc1 Lw0_1
  buffer_load_dword v38, v34, s[12:15], s75 offen sc1
Lw0_1:
  s_waitcnt vmcnt(14)
  s_barrier
  ds_read_b64_tr_b16 v[40:41], v9 offset:16384
  ds_read_b64_tr_b16 v[42:43], v9 offset:16896
  ds_read_b64_tr_b16 v[44:45], v9 offset:18432
  ds_read_b64_tr_b16 v[46:47], v9 offset:18944
  s_waitcnt lgkmcnt(4)
  v_mfma_f32_32x32x16_bf16 v[64:79], v[48:51], v[112:115], v[64:79]
  s_add_u32 m0, s58, 0
  v_add_u32 v3, 128, v3
  v_add_u32 v4, 128, v4
  buffer_load_dwordx4 v3, s[8:11], s26 offen lds
  v_mfma_f32_32x32x16_bf16 v[64:79], v[52:55], v[116:119], v[64:79]
  ds_read_b64_tr_b16 v[48:49], v9 offset:20480
  ds_read_b64_tr_b16 v[50:51], v9 offset:20992
  ds_read_b64_tr_b16 v[52:53], v9 offset:22528
  ds_read_b64_tr_b16 v[54:55], v9 offset:23040
  buffer_load_dwordx4 v4, s[8:11], s26 offen offset:1024 lds
  v_mfma_f32_32x32x16_bf16 v[64:79], v[56:59], v[120:123], v[64:79]
  v_mfma_f32_32x32x16_bf16 v[64:79], v[60:63], v[124:127], v[64:79]
  s_waitcnt vmcnt(14)
  s_barrier
  ds_read_b64_tr_b16 v[56:57], v9 offset:24576
  ds_read_b64_tr_b16 v[58:59], v9 offset:25088
  ds_read_b64_tr_b16 v[60:61], v9 offset:26624
  ds_read_b64_tr_b16 v[62:63], v9 offset:27136
  s_waitcnt lgkmcnt(4)
  v_mfma_f32_32x32x16_bf16 v[64:79], v[40:43], v[128:131], v[64:79]
  s_add_u32 m0, s58, 8192
  s_nop 0
  buffer_load_dwordx4 v3, s[8:11], s27 offen lds
  v_mfma_f32_32x32x16_bf16 v[64:79], v[44:47], v[132:135], v[64:79]
  ds_read_b64_tr_b16 v[40:41], v9 offset:28672
  ds_read_b64_tr_b16 v[42:43], v9 offset:29184
  ds_read_b64_tr_b16 v[44:45], v9 offset:30720
  ds_read_b64_tr_b16 v[46:47], v9 offset:31232
  buffer_load_dwordx4 v4, s[8:11], s27 offen offset:1024 lds
  v_mfma_f32_32x32x16_bf16 v[64:79], v[48:51], v[136:139], v[64:79]
  v_mfma_f32_32x32x16_bf16 v[64:79], v[52:55], v[140:143], v[64:79]
  s_cmp_lg_u32 s3, 0
  s_cbranch_scc1 Lw0_2
  s_waitcnt vmcnt(4)
  v_cmp_ne_u32 vcc, s52, v38
  s_nop 0
  s_cmp_eq_u64 vcc, 0
  s_cbranch_scc1 Lok_4
  s_mov_b32 s60, 20000
Lspin_3:
  s_sleep 4
  buffer_load_dword v38, v34, s[12:15], s75 offen sc1
  s_waitcnt vmcnt(0)
  v_cmp_ne_u32 vcc, s52, v38
  s_nop 0
  s_cmp_eq_u64 vcc, 0
  s_cbranch_scc1 Lok_4
  s_sub_u32 s60, s60, 1
  s_cmp_lg_u32 s60, 0
  s_cbranch_scc1 Lspin_3
Lok_4:
Lw0_2:
  s_waitcnt vmcnt(14)
  s_barrier
  ds_read_b64_tr_b16 v[48:49], v9 offset:32768
  ds_read_b64_tr_b16 v[50:51], v9 offset:33280
  ds_read_b64_tr_b16 v[52:53], v9 offset:34816
  ds_read_b64_tr_b16 v[54:55], v9 offset:35328
  s_waitcnt lgkmcnt(4)
  v_mfma_f32_32x32x16_bf16 v[64:79], v[56:59], v[144:147], v[64:79]
  s_add_u32 m0, s58, 16384
  s_nop 0
  buffer_load_dwordx4 v3, s[8:11], s28 offen lds
  v_mfma_f32_32x32x16_bf16 v[64:79], v[60:63], v[148:151], v[64:79]
  ds_read_b64_tr_b16 v[56:57], v9 offset:36864
  ds_read_b64_tr_b16 v[58:59], v9 offset:37376
  ds_read_b64_tr_b16 v[60:61], v9 offset:38912
  ds_read_b64_tr_b16 v[62:63], v9 offset:39424
  buffer_load_dwordx4 v4, s[8:11], s28 offen offset:1024 lds
  v_mov_b32 v28, 0
  v_mov_b32 v29, 0
  s_mov_b32 s70, 196608
  s_mov_b32 s71, 212992
  buffer_load_dword v21, v37, s[12:15], s70 offen sc1
  buffer_load_dword v22, v35, s[12:15], s71 offen offset:0 sc1
  buffer_load_dword v24, v35, s[12:15], s71 offen offset:256 sc1
  buffer_load_dword v26, v35, s[12:15], s71 offen offset:512 sc1
  v_mfma_f32_32x32x16_bf16 v[64:79], v[40:43], v[152:155], v[64:79]
  s_mov_b32 s71, 225280
  buffer_load_dword v23, v35, s[12:15], s71 offen offset:0 sc1
  buffer_load_dword v25, v35, s[12:15], s71 offen offset:256 sc1
  buffer_load_dword v27, v35, s[12:15], s71 offen offset:512 sc1
  global_load_short_d16_hi v28, v36, s[38:39]
  global_load_short_d16_hi v29, v39, s[38:39] offset:256
  v_mfma_f32_32x32x16_bf16 v[64:79], v[44:47], v[156:159], v[64:79]
  s_waitcnt vmcnt(23)
  s_barrier
  ds_read_b64_tr_b16 v[40:41], v9 offset:40960
  ds_read_b64_tr_b16 v[42:43], v9 offset:41472
  ds_read_b64_tr_b16 v[44:45], v9 offset:43008
  ds_read_b64_tr_b16 v[46:47], v9 offset:43520
  s_waitcnt lgkmcnt(4)
  v_mfma_f32_32x32x16_bf16 v[64:79], v[48:51], v[160:163], v[64:79]
  s_add_u32 m0, s58, 24576
  s_nop 0
  buffer_load_dwordx4 v3, s[8:11], s29 offen lds
  v_mfma_f32_32x32x16_bf16 v[64:79], v[52:55], v[164:167], v[64:79]
  ds_read_b64_tr_b16 v[48:49], v9 offset:45056
  ds_read_b64_tr_b16 v[50:51], v9 offset:45568
  ds_read_b64_tr_b16 v[52:53], v9 offset:47104
  ds_read_b64_tr_b16 v[54:55], v9 offset:47616
  buffer_load_dwordx4 v4, s[8:11], s29 offen offset:1024 lds
  v_mfma_f32_32x32x16_bf16 v[64:79], v[56:59], v[168:171], v[64:79]
  v_mfma_f32_32x32x16_bf16 v[64:79], v[60:63], v[172:175], v[64:79]
  v_lshlrev_b32 v7, 4, v0
  s_add_u32 s70, s3, 0
  s_and_b32 s70, s70, 3
  s_mul_i32 s70, s70, 49152
  v_add_u32 v1, s70, v7
  s_add_u32 s70, s3, 1
  s_and_b32 s70, s70, 3
  s_mul_i32 s70, s70, 49152
  v_add_u32 v2, s70, v7
  s_add_u32 s70, s3, 2
  s_and_b32 s70, s70, 3
  s_mul_i32 s70, s70, 49152
  v_add_u32 v5, s70, v7
  s_add_u32 s70, s3, 3
  s_and_b32 s70, s70, 3
  s_mul_i32 s70, s70, 49152
  v_add_u32 v6, s70, v7
  s_mul_i32 s74, s3, 5120
  v_lshrrev_b32 v38, 5, v0
  v_lshlrev_b32 v38, 4, v38
  v_lshrrev_b32 v39, 2, v0
  v_and_b32 v39, 7, v39
  v_add_u32 v38, v38, v39
  v_mul_u32_u24 v38, 160, v38
  v_and_b32 v39, 3, v0
  v_lshl_add_u32 v8, v39, 3, v38
  v_add_u32 v8, s74, v8
  s_waitcnt vmcnt(23)
  s_barrier
  ds_read_b64_tr_b16 v[56:57], v9 offset:49152
  ds_read_b64_tr_b16 v[58:59], v9 offset:49664
  ds_read_b64_tr_b16 v[60:61], v9 offset:51200
  ds_read_b64_tr_b16 v[62:63], v9 offset:51712
  s_waitcnt lgkmcnt(4)
  v_mfma_f32_32x32x16_bf16 v[64:79], v[40:43], v[176:179], v[64:79]
  s_add_u32 m0, s58, 32768
  s_nop 0
  buffer_load_dwordx4 v3, s[8:11], s30 offen lds
  v_mfma_f32_32x32x16_bf16 v[64:79], v[44:47], v[180:183], v[64:79]
  ds_read_b64_tr_b16 v[40:41], v9 offset:53248
  ds_read_b64_tr_b16 v[42:43], v9 offset:53760
  ds_read_b64_tr_b16 v[44:45], v9 offset:55296
  ds_read_b64_tr_b16 v[46:47], v9 offset:55808
  buffer_load_dwordx4 v4, s[8:11], s30 offen offset:1024 lds
  v_mfma_f32_32x32x16_bf16 v[64:79], v[48:51], v[184:187], v[64:79]
  v_mfma_f32_32x32x16_bf16 v[64:79], v[52:55], v[188:191], v[64:79]
  s_waitcnt vmcnt(4)
  v_and_b32 v30, v15, v28
  v_xor_b32 v31, v30, v28
  v_and_b32 v29, v15, v29
  v_add_f32 v22, v22, v23
  v_add_f32 v24, v24, v25
  v_add_f32 v26, v26, v27
  v_and_b32 v23, 0xffff0000, v22
  v_and_b32 v25, 0xffff0000, v24
  v_and_b32 v27, 0xffff0000, v26
  v_sub_f32 v22, v22, v23
  v_sub_f32 v24, v24, v25
  v_sub_f32 v26, v26, v27
  v_and_b32 v18, 0xffff0000, v22
  v_and_b32 v34, 0xffff0000, v24
  v_and_b32 v36, 0xffff0000, v26
  v_sub_f32 v22, v22, v18
  v_sub_f32 v24, v24, v34
  v_sub_f32 v26, v26, v36
  v_lshrrev_b32 v23, 16, v23
  v_lshrrev_b32 v25, 16, v25
  v_lshrrev_b32 v27, 16, v27
  v_lshrrev_b32 v22, 16, v22
  v_lshrrev_b32 v24, 16, v24
  v_lshrrev_b32 v26, 16, v26
  v_or_b32 v18, v23, v18
  v_or_b32 v34, v25, v34
  v_or_b32 v36, v27, v36
  v_or_b32 v19, v22, v30
  v_or_b32 v35, v24, v31
  v_or_b32 v37, v26, v29
  v_and_b32 v14, 0xffff0000, v21
  s_mov_b32 s70, 0x01000100
  v_perm_b32 v20, v21, v21, s70
  v_rcp_f32 v14, v14
  s_nop 0
  v_mul_f32 v12, 1069066811, v14
  v_mul_f32 v13, -2.0, v14
  v_mfma_f32_32x32x16_bf16 v[80:95], v[16:19], v[18:21], v[80:95]
  s_barrier
  ds_read_b64_tr_b16 v[48:49], v9 offset:57344
  ds_read_b64_tr_b16 v[50:51], v9 offset:57856
  ds_read_b64_tr_b16 v[52:53], v9 offset:59392
  ds_read_b64_tr_b16 v[54:55], v9 offset:59904
  s_waitcnt lgkmcnt(4)
  v_mfma_f32_32x32x16_bf16 v[64:79], v[56:59], v[192:195], v[64:79]
  s_add_u32 m0, s58, 40960
  s_nop 0
  buffer_load_dwordx4 v3, s[8:11], s31 offen lds
  v_mfma_f32_32x32x16_bf16 v[64:79], v[60:63], v[196:199], v[64:79]
  ds_read_b64_tr_b16 v[56:57], v9 offset:61440
  ds_read_b64_tr_b16 v[58:59], v9 offset:61952
  ds_read_b64_tr_b16 v[60:61], v9 offset:63488
  ds_read_b64_tr_b16 v[62:63], v9 offset:64000
  buffer_load_dwordx4 v4, s[8:11], s31 offen offset:1024 lds
  v_mul_f32 v22, v12, v80
  v_mul_f32 v23, v12, v81
  v_mul_f32 v24, v12, v82
  v_mul_f32 v25, v12, v83
  v_exp_f32 v22, v22
  v_exp_f32 v23, v23
  v_exp_f32 v24, v24
  v_exp_f32 v25, v25
  v_add_f32 v22, 1.0, v22
  v_add_f32 v23, 1.0, v23
  v_add_f32 v24, 1.0, v24
  v_add_f32 v25, 1.0, v25
  v_fma_f32 v22, v22, v22, 1.0
  v_fma_f32 v23, v23, v23, 1.0
  v_fma_f32 v24, v24, v24, 1.0
  v_fma_f32 v25, v25, v25, 1.0
  v_mfma_f32_32x32x16_bf16 v[64:79], v[40:43], v[200:203], v[64:79]
  v_rcp_f32 v22, v22
  v_rcp_f32 v23, v23
  v_rcp_f32 v24, v24
  v_rcp_f32 v25, v25
  v_fma_f32 v22, v22, v13, v14
  v_fma_f32 v23, v23, v13, v14
  v_fma_f32 v24, v24, v13, v14
  v_fma_f32 v25, v25, v13, v14
  v_mul_f32 v22, v22, v80
  v_mul_f32 v23, v23, v81
  v_mul_f32 v24, v24, v82
  v_mul_f32 v25, v25, v83
  v_cvt_pk_bf16_f32 v26, v22, v23
  v_cvt_pk_bf16_f32 v27, v24, v25
  v_mul_f32 v22, v12, v84
  v_mul_f32 v23, v12, v85
  v_mul_f32 v24, v12, v86
  v_mul_f32 v25, v12, v87
  v_exp_f32 v22, v22
  v_exp_f32 v23, v23
  v_exp_f32 v24, v24
  v_exp_f32 v25, v25
  v_add_f32 v22, 1.0, v22
  v_add_f32 v23, 1.0, v23
  v_add_f32 v24, 1.0, v24
  v_add_f32 v25, 1.0, v25
  v_fma_f32 v22, v22, v22, 1.0
  v_fma_f32 v23, v23, v23, 1.0
  v_fma_f32 v24, v24, v24, 1.0
  v_fma_f32 v25, v25, v25, 1.0
  v_mfma_f32_32x32x16_bf16 v[64:79], v[44:47], v[204:207], v[64:79]
  s_barrier
  ds_read_b64_tr_b16 v[40:41], v10 offset:0
  ds_read_b64_tr_b16 v[42:43], v10 offset:512
  ds_read_b64_tr_b16 v[44:45], v10 offset:2048
  ds_read_b64_tr_b16 v[46:47], v10 offset:2560
  s_waitcnt lgkmcnt(4)
  v_mfma_f32_32x32x16_bf16 v[64:79], v[48:51], v[208:211], v[64:79]
  s_add_u32 m0, s58, 49152
  s_nop 0
  buffer_load_dwordx4 v3, s[8:11], s32 offen lds
  v_mfma_f32_32x32x16_bf16 v[64:79], v[52:55], v[212:215], v[64:79]
  ds_read_b64_tr_b16 v[48:49], v10 offset:4096
  ds_read_b64_tr_b16 v[50:51], v10 offset:4608
  ds_read_b64_tr_b16 v[52:53], v10 offset:6144
  ds_read_b64_tr_b16 v[54:55], v10 offset:6656
  buffer_load_dwordx4 v4, s[8:11], s32 offen offset:1024 lds
  v_rcp_f32 v22, v22
  v_rcp_f32 v23, v23
  v_rcp_f32 v24, v24
  v_rcp_f32 v25, v25
  v_fma_f32 v22, v22, v13, v14
  v_fma_f32 v23, v23, v13, v14
  v_fma_f32 v24, v24, v13, v14
  v_fma_f32 v25, v25, v13, v14
  v_mul_f32 v22, v22, v84
  v_mul_f32 v23, v23, v85
  v_mul_f32 v24, v24, v86
  v_mul_f32 v25, v25, v87
  v_cvt_pk_bf16_f32 v28, v22, v23
  v_cvt_pk_bf16_f32 v29, v24, v25
  s_add_u32 s68, s61, 0
  buffer_store_dwordx4 v[26:29], v11, s[12:15], s68 offen offset:0 sc1
  v_mfma_f32_32x32x16_bf16 v[64:79], v[56:59], v[216:219], v[64:79]
  v_mul_f32 v22, v12, v88
  v_mul_f32 v23, v12, v89
  v_mul_f32 v24, v12, v90
  v_mul_f32 v25, v12, v91
  v_exp_f32 v22, v22
  v_exp_f32 v23, v23
  v_exp_f32 v24, v24
  v_exp_f32 v25, v25
  v_add_f32 v22, 1.0, v22
  v_add_f32 v23, 1.0, v23
  v_add_f32 v24, 1.0, v24
  v_add_f32 v25, 1.0, v25
  v_fma_f32 v22, v22, v22, 1.0
  v_fma_f32 v23, v23, v23, 1.0
  v_fma_f32 v24, v24, v24, 1.0
  v_fma_f32 v25, v25, v25, 1.0
  v_rcp_f32 v22, v22
  v_rcp_f32 v23, v23
  v_rcp_f32 v24, v24
  v_rcp_f32 v25, v25
  v_fma_f32 v22, v22, v13, v14
  v_fma_f32 v23, v23, v13, v14
  v_fma_f32 v24, v24, v13, v14
  v_fma_f32 v25, v25, v13, v14
  v_mul_f32 v22, v22, v88
  v_mul_f32 v23, v23, v89
  v_mul_f32 v24, v24, v90
  v_mul_f32 v25, v25, v91
  v_cvt_pk_bf16_f32 v30, v22, v23
  v_cvt_pk_bf16_f32 v31, v24, v25
  v_mfma_f32_32x32x16_bf16 v[64:79], v[60:63], v[220:223], v[64:79]
  s_barrier
  ds_read_b64_tr_b16 v[56:57], v10 offset:8192
  ds_read_b64_tr_b16 v[58:59], v10 offset:8704
  ds_read_b64_tr_b16 v[60:61], v10 offset:10240
  ds_read_b64_tr_b16 v[62:63], v10 offset:10752
  s_waitcnt lgkmcnt(4)
  v_mfma_f32_32x32x16_bf16 v[64:79], v[40:43], v[224:227], v[64:79]
  s_add_u32 m0, s58, 57344
  s_nop 0
  buffer_load_dwordx4 v3, s[8:11], s33 offen lds
  v_mfma_f32_32x32x16_bf16 v[64:79], v[44:47], v[228:231], v[64:79]
  ds_read_b64_tr_b16 v[40:41], v10 offset:12288
  ds_read_b64_tr_b16 v[42:43], v10 offset:12800
  ds_read_b64_tr_b16 v[44:45], v10 offset:14336
  ds_read_b64_tr_b16 v[46:47], v10 offset:14848
  buffer_load_dwordx4 v4, s[8:11], s33 offen offset:1024 lds
  v_mul_f32 v22, v12, v92
  v_mul_f32 v23, v12, v93
  v_mul_f32 v24, v12, v94
  v_mul_f32 v25, v12, v95
  v_exp_f32 v22, v22
  v_exp_f32 v23, v23
  v_exp_f32 v24, v24
  v_exp_f32 v25, v25
  v_add_f32 v22, 1.0, v22
  v_add_f32 v23, 1.0, v23
  v_add_f32 v24, 1.0, v24
  v_add_f32 v25, 1.0, v25
  v_fma_f32 v22, v22, v22, 1.0
  v_fma_f32 v23, v23, v23, 1.0
  v_fma_f32 v24, v24, v24, 1.0
  v_fma_f32 v25, v25, v25, 1.0
  v_mfma_f32_32x32x16_bf16 v[64:79], v[48:51], v[232:235], v[64:79]
  v_rcp_f32 v22, v22
  v_rcp_f32 v23, v23
  v_rcp_f32 v24, v24
  v_rcp_f32 v25, v25
  v_fma_f32 v22, v22, v13, v14
  v_fma_f32 v23, v23, v13, v14
  v_fma_f32 v24, v24, v13, v14
  v_fma_f32 v25, v25, v13, v14
  v_mul_f32 v22, v22, v92
  v_mul_f32 v23, v23, v93
  v_mul_f32 v24, v24, v94
  v_mul_f32 v25, v25, v95
  v_cvt_pk_bf16_f32 v32, v22, v23
  v_cvt_pk_bf16_f32 v33, v24, v25
  s_add_u32 s68, s61, 0
  buffer_store_dwordx4 v[30:33], v11, s[12:15], s68 offen offset:512 sc1
  v_mfma_f32_32x32x16_bf16 v[64:79], v[52:55], v[236:239], v[64:79]
  s_barrier
  ds_read_b64_tr_b16 v[48:49], v9 offset:0
  ds_read_b64_tr_b16 v[50:51], v9 offset:512
  ds_read_b64_tr_b16 v[52:53], v9 offset:2048
  ds_read_b64_tr_b16 v[54:55], v9 offset:2560
  s_waitcnt lgkmcnt(4)
  v_mfma_f32_32x32x16_bf16 v[64:79], v[56:59], v[240:243], v[64:79]
  s_add_u32 m0, s58, 65536
  s_nop 0
  buffer_load_dwordx4 v3, s[8:11], s34 offen lds
  v_mfma_f32_32x32x16_bf16 v[64:79], v[60:63], v[244:247], v[64:79]
  ds_read_b64_tr_b16 v[56:57], v9 offset:4096
  ds_read_b64_tr_b16 v[58:59], v9 offset:4608
  ds_read_b64_tr_b16 v[60:61], v9 offset:6144
  ds_read_b64_tr_b16 v[62:63], v9 offset:6656
  buffer_load_dwordx4 v4, s[8:11], s34 offen offset:1024 lds
  v_mfma_f32_32x32x16_bf16 v[64:79], v[40:43], v[248:251], v[64:79]
  v_mfma_f32_32x32x16_bf16 v[64:79], v[44:47], v[252:255], v[64:79]
  v_mov_b32 v18, v34
  v_mov_b32 v19, v35
  s_nop 1
  v_mfma_f32_32x32x16_bf16 v[64:79], v[16:19], v[18:21], v[64:79]
  s_barrier
  ds_read_b64_tr_b16 v[40:41], v9 offset:8192
  ds_read_b64_tr_b16 v[42:43], v9 offset:8704
  ds_read_b64_tr_b16 v[44:45], v9 offset:10240
  ds_read_b64_tr_b16 v[46:47], v9 offset:10752
  s_waitcnt lgkmcnt(4)
  v_mfma_f32_32x32x16_bf16 v[80:95], v[48:51], v[96:99], 0
  s_add_u32 m0, s58, 73728
  s_nop 0
  buffer_load_dwordx4 v3, s[8:11], s35 offen lds
  v_mfma_f32_32x32x16_bf16 v[80:95], v[52:55], v[100:103], v[80:95]
  ds_read_b64_tr_b16 v[48:49], v9 offset:12288
  ds_read_b64_tr_b16 v[50:51], v9 offset:12800
  ds_read_b64_tr_b16 v[52:53], v9 offset:14336
  ds_read_b64_tr_b16 v[54:55], v9 offset:14848
  buffer_load_dwordx4 v4, s[8:11], s35 offen offset:1024 lds
  v_mul_f32 v22, v12, v64
  v_mul_f32 v23, v12, v65
  v_mul_f32 v24, v12, v66
  v_mul_f32 v25, v12, v67
  v_exp_f32 v22, v22
  v_exp_f32 v23, v23
  v_exp_f32 v24, v24
  v_exp_f32 v25, v25
  v_add_f32 v22, 1.0, v22
  v_add_f32 v23, 1.0, v23
  v_add_f32 v24, 1.0, v24
  v_add_f32 v25, 1.0, v25
  v_fma_f32 v22, v22, v22, 1.0
  v_fma_f32 v23, v23, v23, 1.0
  v_fma_f32 v24, v24, v24, 1.0
  v_fma_f32 v25, v25, v25, 1.0
  v_mfma_f32_32x32x16_bf16 v[80:95], v[56:59], v[104:107], v[80:95]
  v_rcp_f32 v22, v22
  v_rcp_f32 v23, v23
  v_rcp_f32 v24, v24
  v_rcp_f32 v25, v25
  v_fma_f32 v22, v22, v13, v14
  v_fma_f32 v23, v23, v13, v14
  v_fma_f32 v24, v24, v13, v14
  v_fma_f32 v25, v25, v13, v14
  v_mul_f32 v22, v22, v64
  v_mul_f32 v23, v23, v65
  v_mul_f32 v24, v24, v66
  v_mul_f32 v25, v25, v67
  v_cvt_pk_bf16_f32 v26, v22, v23
  v_cvt_pk_bf16_f32 v27, v24, v25
  v_mul_f32 v22, v12, v68
  v_mul_f32 v23, v12, v69
  v_mul_f32 v24, v12, v70
  v_mul_f32 v25, v12, v71
  v_exp_f32 v22, v22
  v_exp_f32 v23, v23
  v_exp_f32 v24, v24
  v_exp_f32 v25, v25
  v_add_f32 v22, 1.0, v22
  v_add_f32 v23, 1.0, v23
  v_add_f32 v24, 1.0, v24
  v_add_f32 v25, 1.0, v25
  v_fma_f32 v22, v22, v22, 1.0
  v_fma_f32 v23, v23, v23, 1.0
  v_fma_f32 v24, v24, v24, 1.0
  v_fma_f32 v25, v25, v25, 1.0
  v_mfma_f32_32x32x16_bf16 v[80:95], v[60:63], v[108:111], v[80:95]
  v_lshlrev_b32 v98, 7, v0
  s_cmp_lg_u32 s3, 0
  s_cbranch_scc1 Lw0_5
  s_mov_b32 s76, 425984
  buffer_load_dword v99, v98, s[12:15], s76 offen sc1
  s_mov_b32 s76, 434176
  buffer_load_dword v100, v98, s[12:15], s76 offen sc1
Lw0_5:
  s_waitcnt vmcnt(4)
  s_barrier
  s_add_u32 s70, s81, 0
  v_mov_b32 v38, s52
  v_mov_b32 v39, 0
  s_mov_b64 exec, 1
  buffer_store_dword v38, v39, s[12:15], s70 offen sc1
  s_mov_b64 exec, -1
  ds_read_b64_tr_b16 v[56:57], v9 offset:16384
  ds_read_b64_tr_b16 v[58:59], v9 offset:16896
  ds_read_b64_tr_b16 v[60:61], v9 offset:18432
  ds_read_b64_tr_b16 v[62:63], v9 offset:18944
  s_waitcnt lgkmcnt(4)
  v_mfma_f32_32x32x16_bf16 v[80:95], v[40:43], v[112:115], v[80:95]
  v_mfma_f32_32x32x16_bf16 v[80:95], v[44:47], v[116:119], v[80:95]
  ds_read_b64_tr_b16 v[40:41], v9 offset:20480
  ds_read_b64_tr_b16 v[42:43], v9 offset:20992
  ds_read_b64_tr_b16 v[44:45], v9 offset:22528
  ds_read_b64_tr_b16 v[46:47], v9 offset:23040
  v_rcp_f32 v22, v22
  v_rcp_f32 v23, v23
  v_rcp_f32 v24, v24
  v_rcp_f32 v25, v25
  v_fma_f32 v22, v22, v13, v14
  v_fma_f32 v23, v23, v13, v14
  v_fma_f32 v24, v24, v13, v14
  v_fma_f32 v25, v25, v13, v14
  v_mul_f32 v22, v22, v68
  v_mul_f32 v23, v23, v69
  v_mul_f32 v24, v24, v70
  v_mul_f32 v25, v25, v71
  v_cvt_pk_bf16_f32 v28, v22, v23
  v_cvt_pk_bf16_f32 v29, v24, v25
  s_add_u32 s68, s61, 2048
  buffer_store_dwordx4 v[26:29], v11, s[12:15], s68 offen offset:0 sc1
  v_mfma_f32_32x32x16_bf16 v[80:95], v[48:51], v[120:123], v[80:95]
  v_mul_f32 v22, v12, v72
  v_mul_f32 v23, v12, v73
  v_mul_f32 v24, v12, v74
  v_mul_f32 v25, v12, v75
  v_exp_f32 v22, v22
  v_exp_f32 v23, v23
  v_exp_f32 v24, v24
  v_exp_f32 v25, v25
  v_add_f32 v22, 1.0, v22
  v_add_f32 v23, 1.0, v23
  v_add_f32 v24, 1.0, v24
  v_add_f32 v25, 1.0, v25
  v_fma_f32 v22, v22, v22, 1.0
  v_fma_f32 v23, v23, v23, 1.0
  v_fma_f32 v24, v24, v24, 1.0
  v_fma_f32 v25, v25, v25, 1.0
  v_rcp_f32 v22, v22
  v_rcp_f32 v23, v23
  v_rcp_f32 v24, v24
  v_rcp_f32 v25, v25
  v_fma_f32 v22, v22, v13, v14
  v_fma_f32 v23, v23, v13, v14
  v_fma_f32 v24, v24, v13, v14
  v_fma_f32 v25, v25, v13, v14
  v_mul_f32 v22, v22, v72
  v_mul_f32 v23, v23, v73
  v_mul_f32 v24, v24, v74
  v_mul_f32 v25, v25, v75
  v_cvt_pk_bf16_f32 v30, v22, v23
  v_cvt_pk_bf16_f32 v31, v24, v25
  v_mfma_f32_32x32x16_bf16 v[80:95], v[52:55], v[124:127], v[80:95]
  s_and_b32 s70, s55, 3
  s_lshl_b32 s70, s70, 1
  s_add_u32 s70, s70, s54
  s_mul_i32 s70, s70, 0
  s_add_u32 s70, s70, s57
  s_mul_i32 s72, s54, 192
  s_add_u32 s72, s72, s56
  s_lshl_b32 s72, s72, 10
  s_add_u32 s72, s72, 10485760
  s_mul_i32 s73, s55, 245760
  s_mul_i32 s71, s56, 5120
  s_add_u32 s73, s73, s71
  s_add_u32 s73, s73, 7340032
  s_and_b32 s70, s70, 7
  s_mul_i32 s71, s70, 6144
  s_add_u32 s16, s71, s72
  s_mul_i32 s71, s70, 30720
  s_add_u32 s26, s71, s73
  s_add_u32 s70, s70, 2
  s_and_b32 s70, s70, 7
  s_mul_i32 s71, s70, 6144
  s_add_u32 s17, s71, s72
  s_mul_i32 s71, s70, 30720
  s_add_u32 s27, s71, s73
  s_add_u32 s70, s70, 2
  s_and_b32 s70, s70, 7
  s_mul_i32 s71, s70, 6144
  s_add_u32 s18, s71, s72
  s_mul_i32 s71, s70, 30720
  s_add_u32 s28, s71, s73
  s_add_u32 s70, s70, 2
  s_and_b32 s70, s70, 7
  s_mul_i32 s71, s70, 6144
  s_add_u32 s19, s71, s72
  s_mul_i32 s71, s70, 30720
  s_add_u32 s29, s71, s73
  s_add_u32 s70, s70, 2
  s_lshl_b32 s70, s3, 4
  s_lshl_b32 s71, s54, 6
  s_add_u32 s70, s70, s71
  v_and_b32 v38, 15, v0
  v_add_u32 v38, s70, v38
  v_mul_u32_u24 v38, 0x500, v38
  v_lshrrev_b32 v39, 4, v0
  v_lshl_add_u32 v38, v39, 3, v38
  s_mul_i32 s70, s55, 160
  v_add_u32 v3, s70, v38
  v_and_b32 v4, 31, v0
  v_lshlrev_b32 v4, 7, v4
  s_mul_i32 s78, s54, 12288
  s_add_u32 s78, s78, 16777216
  s_add_u32 s79, s78, 4096
  s_add_u32 s80, s78, 8192
  s_barrier
  ds_read_b64_tr_b16 v[48:49], v9 offset:24576
  ds_read_b64_tr_b16 v[50:51], v9 offset:25088
  ds_read_b64_tr_b16 v[52:53], v9 offset:26624
  ds_read_b64_tr_b16 v[54:55], v9 offset:27136
  s_waitcnt lgkmcnt(4)
  v_mfma_f32_32x32x16_bf16 v[80:95], v[56:59], v[128:131], v[80:95]
  v_mfma_f32_32x32x16_bf16 v[80:95], v[60:63], v[132:135], v[80:95]
  ds_read_b64_tr_b16 v[56:57], v9 offset:28672
  ds_read_b64_tr_b16 v[58:59], v9 offset:29184
  ds_read_b64_tr_b16 v[60:61], v9 offset:30720
  ds_read_b64_tr_b16 v[62:63], v9 offset:31232
  v_mul_f32 v22, v12, v76
  v_mul_f32 v23, v12, v77
  v_mul_f32 v24, v12, v78
  v_mul_f32 v25, v12, v79
  v_exp_f32 v22, v22
  v_exp_f32 v23, v23
  v_exp_f32 v24, v24
  v_exp_f32 v25, v25
  v_add_f32 v22, 1.0, v22
  v_add_f32 v23, 1.0, v23
  v_add_f32 v24, 1.0, v24
  v_add_f32 v25, 1.0, v25
  v_fma_f32 v22, v22, v22, 1.0
  v_fma_f32 v23, v23, v23, 1.0
  v_fma_f32 v24, v24, v24, 1.0
  v_fma_f32 v25, v25, v25, 1.0
  v_mfma_f32_32x32x16_bf16 v[80:95], v[40:43], v[136:139], v[80:95]
  v_rcp_f32 v22, v22
  v_rcp_f32 v23, v23
  v_rcp_f32 v24, v24
  v_rcp_f32 v25, v25
  v_fma_f32 v22, v22, v13, v14
  v_fma_f32 v23, v23, v13, v14
  v_fma_f32 v24, v24, v13, v14
  v_fma_f32 v25, v25, v13, v14
  v_mul_f32 v22, v22, v76
  v_mul_f32 v23, v23, v77
  v_mul_f32 v24, v24, v78
  v_mul_f32 v25, v25, v79
  v_cvt_pk_bf16_f32 v32, v22, v23
  v_cvt_pk_bf16_f32 v33, v24, v25
  s_add_u32 s68, s61, 2048
  buffer_store_dwordx4 v[30:33], v11, s[12:15], s68 offen offset:512 sc1
  v_mfma_f32_32x32x16_bf16 v[80:95], v[44:47], v[140:143], v[80:95]
  s_cmp_lg_u32 s3, 0
  s_cbranch_scc1 Lw0_6
  s_waitcnt vmcnt(3)
  v_cmp_ne_u32 s[62:63], s52, v100
  v_cmp_ne_u32 vcc, s52, v99
  s_nop 0
  s_or_b64 vcc, vcc, s[62:63]
  s_cmp_eq_u64 vcc, 0
  s_cbranch_scc1 Lok_8
  s_mov_b32 s60, 20000
Lspin_7:
  s_sleep 4
  s_mov_b32 s76, 425984
  buffer_load_dword v99, v98, s[12:15], s76 offen sc1
  s_mov_b32 s76, 434176
  buffer_load_dword v100, v98, s[12:15], s76 offen sc1
  s_waitcnt vmcnt(0)
  v_cmp_ne_u32 s[62:63], s52, v100
  v_cmp_ne_u32 vcc, s52, v99
  s_nop 0
  s_or_b64 vcc, vcc, s[62:63]
  s_cmp_eq_u64 vcc, 0
  s_cbranch_scc1 Lok_8
  s_sub_u32 s60, s60, 1
  s_cmp_lg_u32 s60, 0
  s_cbranch_scc1 Lspin_7
Lok_8:
Lw0_6:
  s_barrier
  ds_read_b64_tr_b16 v[40:41], v9 offset:32768
  ds_read_b64_tr_b16 v[42:43], v9 offset:33280
  ds_read_b64_tr_b16 v[44:45], v9 offset:34816
  ds_read_b64_tr_b16 v[46:47], v9 offset:35328
  s_waitcnt lgkmcnt(4)
  v_mfma_f32_32x32x16_bf16 v[80:95], v[48:51], v[144:147], v[80:95]
  s_add_u32 m0, s74, 0
  s_nop 0
  buffer_load_dwordx4 v7, s[12:15], s26 offen offset:0 sc1 lds
  buffer_load_dwordx4 v7, s[12:15], s26 offen offset:1024 sc1 lds
  v_mfma_f32_32x32x16_bf16 v[80:95], v[52:55], v[148:151], v[80:95]
  ds_read_b64_tr_b16 v[48:49], v9 offset:36864
  ds_read_b64_tr_b16 v[50:51], v9 offset:37376
  ds_read_b64_tr_b16 v[52:53], v9 offset:38912
  ds_read_b64_tr_b16 v[54:55], v9 offset:39424
  buffer_load_dwordx4 v7, s[12:15], s26 offen offset:2048 sc1 lds
  buffer_load_dwordx4 v7, s[12:15], s26 offen offset:3072 sc1 lds
  v_mfma_f32_32x32x16_bf16 v[80:95], v[56:59], v[152:155], v[80:95]
  s_add_u32 m0, s74, 4096
  s_add_u32 s70, s26, 4096
  buffer_load_dwordx4 v7, s[12:15], s70 offen offset:0 sc1 lds
  v_mfma_f32_32x32x16_bf16 v[80:95], v[60:63], v[156:159], v[80:95]
  s_barrier
  ds_read_b64_tr_b16 v[56:57], v9 offset:40960
  ds_read_b64_tr_b16 v[58:59], v9 offset:41472
  ds_read_b64_tr_b16 v[60:61], v9 offset:43008
  ds_read_b64_tr_b16 v[62:63], v9 offset:43520
  s_waitcnt lgkmcnt(4)
  v_mfma_f32_32x32x16_bf16 v[80:95], v[40:43], v[160:163], v[80:95]
  v_mfma_f32_32x32x16_bf16 v[80:95], v[44:47], v[164:167], v[80:95]
  ds_read_b64_tr_b16 v[40:41], v9 offset:45056
  ds_read_b64_tr_b16 v[42:43], v9 offset:45568
  ds_read_b64_tr_b16 v[44:45], v9 offset:47104
  ds_read_b64_tr_b16 v[46:47], v9 offset:47616
  v_mfma_f32_32x32x16_bf16 v[80:95], v[48:51], v[168:171], v[80:95]
  v_mfma_f32_32x32x16_bf16 v[80:95], v[52:55], v[172:175], v[80:95]
  s_waitcnt vmcnt(5)
  s_barrier
  s_add_u32 s70, s81, 4096
  v_mov_b32 v38, s52
  v_mov_b32 v39, 0
  s_mov_b64 exec, 1
  buffer_store_dword v38, v39, s[12:15], s70 offen sc1
  s_mov_b64 exec, -1
  ds_read_b64_tr_b16 v[48:49], v9 offset:49152
  ds_read_b64_tr_b16 v[50:51], v9 offset:49664
  ds_read_b64_tr_b16 v[52:53], v9 offset:51200
  ds_read_b64_tr_b16 v[54:55], v9 offset:51712
  s_waitcnt lgkmcnt(4)
  v_mfma_f32_32x32x16_bf16 v[80:95], v[56:59], v[176:179], v[80:95]
  s_add_u32 m0, s74, 20480
  s_nop 0
  buffer_load_dwordx4 v7, s[12:15], s27 offen offset:0 sc1 lds
  buffer_load_dwordx4 v7, s[12:15], s27 offen offset:1024 sc1 lds
  v_mfma_f32_32x32x16_bf16 v[80:95], v[60:63], v[180:183], v[80:95]
  ds_read_b64_tr_b16 v[56:57], v9 offset:53248
  ds_read_b64_tr_b16 v[58:59], v9 offset:53760
  ds_read_b64_tr_b16 v[60:61], v9 offset:55296
  ds_read_b64_tr_b16 v[62:63], v9 offset:55808
  buffer_load_dwordx4 v7, s[12:15], s27 offen offset:2048 sc1 lds
  buffer_load_dwordx4 v7, s[12:15], s27 offen offset:3072 sc1 lds
  v_mfma_f32_32x32x16_bf16 v[80:95], v[40:43], v[184:187], v[80:95]
  s_add_u32 m0, s74, 24576
  s_add_u32 s70, s27, 4096
  buffer_load_dwordx4 v7, s[12:15], s70 offen offset:0 sc1 lds
  v_mfma_f32_32x32x16_bf16 v[80:95], v[44:47], v[188:191], v[80:95]
  s_barrier
  ds_read_b64_tr_b16 v[40:41], v9 offset:57344
  ds_read_b64_tr_b16 v[42:43], v9 offset:57856
  ds_read_b64_tr_b16 v[44:45], v9 offset:59392
  ds_read_b64_tr_b16 v[46:47], v9 offset:59904
  s_waitcnt lgkmcnt(4)
  v_mfma_f32_32x32x16_bf16 v[80:95], v[48:51], v[192:195], v[80:95]
  v_mfma_f32_32x32x16_bf16 v[80:95], v[52:55], v[196:199], v[80:95]
  ds_read_b64_tr_b16 v[48:49], v9 offset:61440
  ds_read_b64_tr_b16 v[50:51], v9 offset:61952
  ds_read_b64_tr_b16 v[52:53], v9 offset:63488
  ds_read_b64_tr_b16 v[54:55], v9 offset:64000
  v_mfma_f32_32x32x16_bf16 v[80:95], v[56:59], v[200:203], v[80:95]
  v_mfma_f32_32x32x16_bf16 v[80:95], v[60:63], v[204:207], v[80:95]
  s_barrier
  ds_read_b64_tr_b16 v[56:57], v10 offset:0
  ds_read_b64_tr_b16 v[58:59], v10 offset:512
  ds_read_b64_tr_b16 v[60:61], v10 offset:2048
  ds_read_b64_tr_b16 v[62:63], v10 offset:2560
  s_waitcnt lgkmcnt(4)
  v_mfma_f32_32x32x16_bf16 v[80:95], v[40:43], v[208:211], v[80:95]
  v_mfma_f32_32x32x16_bf16 v[80:95], v[44:47], v[212:215], v[80:95]
  ds_read_b64_tr_b16 v[40:41], v10 offset:4096
  ds_read_b64_tr_b16 v[42:43], v10 offset:4608
  ds_read_b64_tr_b16 v[44:45], v10 offset:6144
  ds_read_b64_tr_b16 v[46:47], v10 offset:6656
  v_mfma_f32_32x32x16_bf16 v[80:95], v[48:51], v[216:219], v[80:95]
  v_mfma_f32_32x32x16_bf16 v[80:95], v[52:55], v[220:223], v[80:95]
  buffer_load_dword v143, v4, s[12:15], s78 offen sc1
  s_barrier
  ds_read_b64_tr_b16 v[48:49], v10 offset:8192
  ds_read_b64_tr_b16 v[50:51], v10 offset:8704
  ds_read_b64_tr_b16 v[52:53], v10 offset:10240
  ds_read_b64_tr_b16 v[54:55], v10 offset:10752
  s_waitcnt lgkmcnt(4)
  v_mfma_f32_32x32x16_bf16 v[80:95], v[56:59], v[224:227], v[80:95]
  s_add_u32 m0, s74, 40960
  s_nop 0
  buffer_load_dwordx4 v7, s[12:15], s28 offen offset:0 sc1 lds
  buffer_load_dwordx4 v7, s[12:15], s28 offen offset:1024 sc1 lds
  v_mfma_f32_32x32x16_bf16 v[80:95], v[60:63], v[228:231], v[80:95]
  ds_read_b64_tr_b16 v[56:57], v10 offset:12288
  ds_read_b64_tr_b16 v[58:59], v10 offset:12800
  ds_read_b64_tr_b16 v[60:61], v10 offset:14336
  ds_read_b64_tr_b16 v[62:63], v10 offset:14848
  buffer_load_dwordx4 v7, s[12:15], s28 offen offset:2048 sc1 lds
  buffer_load_dwordx4 v7, s[12:15], s28 offen offset:3072 sc1 lds
  v_mfma_f32_32x32x16_bf16 v[80:95], v[40:43], v[232:235], v[80:95]
  s_add_u32 m0, s74, 45056
  s_add_u32 s70, s28, 4096
  buffer_load_dwordx4 v7, s[12:15], s70 offen offset:0 sc1 lds
  v_mfma_f32_32x32x16_bf16 v[80:95], v[44:47], v[236:239], v[80:95]
  s_waitcnt lgkmcnt(0)
  s_barrier
  v_mfma_f32_32x32x16_bf16 v[80:95], v[48:51], v[240:243], v[80:95]
  v_mfma_f32_32x32x16_bf16 v[80:95], v[52:55], v[244:247], v[80:95]
  v_mfma_f32_32x32x16_bf16 v[80:95], v[56:59], v[248:251], v[80:95]
  v_mfma_f32_32x32x16_bf16 v[80:95], v[60:63], v[252:255], v[80:95]
  s_add_u32 m0, s74, 61440
  s_nop 0
  buffer_load_dwordx4 v7, s[12:15], s29 offen offset:0 sc1 lds
  buffer_load_dwordx4 v7, s[12:15], s29 offen offset:1024 sc1 lds
  buffer_load_dwordx4 v7, s[12:15], s29 offen offset:2048 sc1 lds
  buffer_load_dwordx4 v7, s[12:15], s29 offen offset:3072 sc1 lds
  s_add_u32 m0, s74, 65536
  s_add_u32 s70, s29, 4096
  buffer_load_dwordx4 v7, s[12:15], s70 offen offset:0 sc1 lds
  v_mov_b32 v18, v36
  v_mov_b32 v19, v37
  s_nop 1
  v_mfma_f32_32x32x16_bf16 v[80:95], v[16:19], v[18:21], v[80:95]
  s_nop 11
  v_mul_f32 v22, v12, v80
  v_mul_f32 v23, v12, v81
  v_mul_f32 v24, v12, v82
  v_mul_f32 v25, v12, v83
  v_exp_f32 v22, v22
  v_exp_f32 v23, v23
  v_exp_f32 v24, v24
  v_exp_f32 v25, v25
  v_add_f32 v22, 1.0, v22
  v_add_f32 v23, 1.0, v23
  v_add_f32 v24, 1.0, v24
  v_add_f32 v25, 1.0, v25
  v_fma_f32 v22, v22, v22, 1.0
  v_fma_f32 v23, v23, v23, 1.0
  v_fma_f32 v24, v24, v24, 1.0
  v_fma_f32 v25, v25, v25, 1.0
  v_rcp_f32 v22, v22
  v_rcp_f32 v23, v23
  v_rcp_f32 v24, v24
  v_rcp_f32 v25, v25
  v_fma_f32 v22, v22, v13, v14
  v_fma_f32 v23, v23, v13, v14
  v_fma_f32 v24, v24, v13, v14
  v_fma_f32 v25, v25, v13, v14
  v_mul_f32 v22, v22, v80
  v_mul_f32 v23, v23, v81
  v_mul_f32 v24, v24, v82
  v_mul_f32 v25, v25, v83
  v_cvt_pk_bf16_f32 v26, v22, v23
  v_cvt_pk_bf16_f32 v27, v24, v25
  s_waitcnt vmcnt(10)
  v_cmp_ne_u32 vcc, s52, v143
  s_nop 0
  s_cmp_eq_u64 vcc, 0
  s_cbranch_scc1 Lok_10
  s_mov_b32 s60, 20000
Lspin_9:
  s_sleep 4
  buffer_load_dword v143, v4, s[12:15], s78 offen sc1
  s_waitcnt vmcnt(0)
  v_cmp_ne_u32 vcc, s52, v143
  s_nop 0
  s_cmp_eq_u64 vcc, 0
  s_cbranch_scc1 Lok_10
  s_sub_u32 s60, s60, 1
  s_cmp_lg_u32 s60, 0
  s_cbranch_scc1 Lspin_9
Lok_10:
  buffer_load_dwordx4 v[96:99], v1, s[12:15], s16 offen sc1
  buffer_load_dwordx4 v[100:103], v2, s[12:15], s16 offen sc1
  buffer_load_dwordx4 v[104:107], v5, s[12:15], s16 offen sc1
  buffer_load_dwordx4 v[108:111], v6, s[12:15], s16 offen sc1
  v_mul_f32 v22, v12, v84
  v_mul_f32 v23, v12, v85
  v_mul_f32 v24, v12, v86
  v_mul_f32 v25, v12, v87
  v_exp_f32 v22, v22
  v_exp_f32 v23, v23
  v_exp_f32 v24, v24
  v_exp_f32 v25, v25
  v_add_f32 v22, 1.0, v22
  v_add_f32 v23, 1.0, v23
  v_add_f32 v24, 1.0, v24
  v_add_f32 v25, 1.0, v25
  v_fma_f32 v22, v22, v22, 1.0
  v_fma_f32 v23, v23, v23, 1.0
  v_fma_f32 v24, v24, v24, 1.0
  v_fma_f32 v25, v25, v25, 1.0
  buffer_load_dwordx4 v[112:115], v1, s[12:15], s17 offen sc1
  buffer_load_dwordx4 v[116:119], v2, s[12:15], s17 offen sc1
  buffer_load_dwordx4 v[120:123], v5, s[12:15], s17 offen sc1
  buffer_load_dwordx4 v[124:127], v6, s[12:15], s17 offen sc1
  v_rcp_f32 v22, v22
  v_rcp_f32 v23, v23
  v_rcp_f32 v24, v24
  v_rcp_f32 v25, v25
  v_fma_f32 v22, v22, v13, v14
  v_fma_f32 v23, v23, v13, v14
  v_fma_f32 v24, v24, v13, v14
  v_fma_f32 v25, v25, v13, v14
  v_mul_f32 v22, v22, v84
  v_mul_f32 v23, v23, v85
  v_mul_f32 v24, v24, v86
  v_mul_f32 v25, v25, v87
  v_cvt_pk_bf16_f32 v28, v22, v23
  v_cvt_pk_bf16_f32 v29, v24, v25
  s_add_u32 s68, s61, 4096
  buffer_store_dwordx4 v[26:29], v11, s[12:15], s68 offen offset:0 sc1
  buffer_load_dwordx4 v[128:131], v1, s[12:15], s18 offen sc1
  buffer_load_dwordx4 v[132:135], v2, s[12:15], s18 offen sc1
  buffer_load_dwordx4 v[136:139], v5, s[12:15], s18 offen sc1
  buffer_load_dwordx4 v[140:143], v6, s[12:15], s18 offen sc1
  v_mul_f32 v22, v12, v88
  v_mul_f32 v23, v12, v89
  v_mul_f32 v24, v12, v90
  v_mul_f32 v25, v12, v91
  v_exp_f32 v22, v22
  v_exp_f32 v23, v23
  v_exp_f32 v24, v24
  v_exp_f32 v25, v25
  v_add_f32 v22, 1.0, v22
  v_add_f32 v23, 1.0, v23
  v_add_f32 v24, 1.0, v24
  v_add_f32 v25, 1.0, v25
  v_fma_f32 v22, v22, v22, 1.0
  v_fma_f32 v23, v23, v23, 1.0
  v_fma_f32 v24, v24, v24, 1.0
  v_fma_f32 v25, v25, v25, 1.0
  buffer_load_dwordx4 v[144:147], v1, s[12:15], s19 offen sc1
  buffer_load_dwordx4 v[148:151], v2, s[12:15], s19 offen sc1
  buffer_load_dwordx4 v[152:155], v5, s[12:15], s19 offen sc1
  buffer_load_dwordx4 v[156:159], v6, s[12:15], s19 offen sc1
  v_rcp_f32 v22, v22
  v_rcp_f32 v23, v23
  v_rcp_f32 v24, v24
  v_rcp_f32 v25, v25
  v_fma_f32 v22, v22, v13, v14
  v_fma_f32 v23, v23, v13, v14
  v_fma_f32 v24, v24, v13, v14
  v_fma_f32 v25, v25, v13, v14
  v_mul_f32 v22, v22, v88
  v_mul_f32 v23, v23, v89
  v_mul_f32 v24, v24, v90
  v_mul_f32 v25, v25, v91
  v_cvt_pk_bf16_f32 v30, v22, v23
  v_cvt_pk_bf16_f32 v31, v24, v25
  v_mul_f32 v22, v12, v92
  v_mul_f32 v23, v12, v93
  v_mul_f32 v24, v12, v94
  v_mul_f32 v25, v12, v95
  v_exp_f32 v22, v22
  v_exp_f32 v23, v23
  v_exp_f32 v24, v24
  v_exp_f32 v25, v25
  v_add_f32 v22, 1.0, v22
  v_add_f32 v23, 1.0, v23
  v_add_f32 v24, 1.0, v24
  v_add_f32 v25, 1.0, v25
  v_fma_f32 v22, v22, v22, 1.0
  v_fma_f32 v23, v23, v23, 1.0
  v_fma_f32 v24, v24, v24, 1.0
  v_fma_f32 v25, v25, v25, 1.0
  v_rcp_f32 v22, v22
  v_rcp_f32 v23, v23
  v_rcp_f32 v24, v24
  v_rcp_f32 v25, v25
  v_fma_f32 v22, v22, v13, v14
  v_fma_f32 v23, v23, v13, v14
  v_fma_f32 v24, v24, v13, v14
  v_fma_f32 v25, v25, v13, v14
  v_mul_f32 v22, v22, v92
  v_mul_f32 v23, v23, v93
  v_mul_f32 v24, v24, v94
  v_mul_f32 v25, v25, v95
  v_cvt_pk_bf16_f32 v32, v22, v23
  v_cvt_pk_bf16_f32 v33, v24, v25
  s_add_u32 s68, s61, 4096
  buffer_store_dwordx4 v[30:33], v11, s[12:15], s68 offen offset:512 sc1
  buffer_load_dword v9, v4, s[12:15], s79 offen sc1
  s_waitcnt vmcnt(15) lgkmcnt(0)
  ds_read_b64_tr_b16 v[216:217], v8 offset:0
  ds_read_b64_tr_b16 v[218:219], v8 offset:1280
  ds_read_b64_tr_b16 v[220:221], v8 offset:32
  ds_read_b64_tr_b16 v[222:223], v8 offset:1312
  ds_read_b64_tr_b16 v[224:225], v8 offset:64
  ds_read_b64_tr_b16 v[226:227], v8 offset:1344
  ds_read_b64_tr_b16 v[228:229], v8 offset:96
  ds_read_b64_tr_b16 v[230:231], v8 offset:1376
  ds_read_b64_tr_b16 v[232:233], v8 offset:128
  ds_read_b64_tr_b16 v[234:235], v8 offset:1408
  s_waitcnt vmcnt(0)
  v_cmp_ne_u32 vcc, s52, v9
  s_nop 0
  s_cmp_eq_u64 vcc, 0
  s_cbranch_scc1 Lok_12
  s_mov_b32 s60, 20000
Lspin_11:
  s_sleep 4
  buffer_load_dword v9, v4, s[12:15], s79 offen sc1
  s_waitcnt vmcnt(0)
  v_cmp_ne_u32 vcc, s52, v9
  s_nop 0
  s_cmp_eq_u64 vcc, 0
  s_cbranch_scc1 Lok_12
  s_sub_u32 s60, s60, 1
  s_cmp_lg_u32 s60, 0
  s_cbranch_scc1 Lspin_11
Lok_12:
  s_waitcnt lgkmcnt(0)
  s_add_u32 s70, s81, 8192
  v_mov_b32 v38, s52
  v_mov_b32 v39, 0
  s_mov_b64 exec, 1
  buffer_store_dword v38, v39, s[12:15], s70 offen sc1
  s_mov_b64 exec, -1
  ds_read_b64_tr_b16 v[236:237], v8 offset:20480
  ds_read_b64_tr_b16 v[238:239], v8 offset:21760
  v_mfma_f32_16x16x32_bf16 v[60:63], v[216:219], v[100:103], 0
  v_mfma_f32_16x16x32_bf16 v[176:179], v[216:219], v[104:107], 0
  s_add_u32 m0, s74, 0
  v_add_u32 v7, 10240, v7
  buffer_load_dwordx4 v7, s[12:15], s26 offen offset:0 sc1 lds
  v_mfma_f32_16x16x32_bf16 v[196:199], v[216:219], v[108:111], 0
  v_mfma_f32_16x16x32_bf16 v[40:43], v[216:219], v[96:99], 0
  buffer_load_dwordx4 v7, s[12:15], s26 offen offset:1024 sc1 lds
  ds_read_b64_tr_b16 v[240:241], v8 offset:20512
  ds_read_b64_tr_b16 v[242:243], v8 offset:21792
  v_mfma_f32_16x16x32_bf16 v[64:67], v[220:223], v[100:103], 0
  v_mfma_f32_16x16x32_bf16 v[180:183], v[220:223], v[104:107], 0
  buffer_load_dwordx4 v7, s[12:15], s26 offen offset:2048 sc1 lds
  v_mfma_f32_16x16x32_bf16 v[200:203], v[220:223], v[108:111], 0
  v_mfma_f32_16x16x32_bf16 v[44:47], v[220:223], v[96:99], 0
  buffer_load_dwordx4 v7, s[12:15], s26 offen offset:3072 sc1 lds
  ds_read_b64_tr_b16 v[244:245], v8 offset:20544
  ds_read_b64_tr_b16 v[246:247], v8 offset:21824
  v_mfma_f32_16x16x32_bf16 v[68:71], v[224:227], v[100:103], 0
  v_mfma_f32_16x16x32_bf16 v[184:187], v[224:227], v[104:107], 0
  s_add_u32 m0, s74, 4096
  s_add_u32 s70, s26, 4096
  buffer_load_dwordx4 v7, s[12:15], s70 offen offset:0 sc1 lds
  v_mfma_f32_16x16x32_bf16 v[204:207], v[224:227], v[108:111], 0
  v_mfma_f32_16x16x32_bf16 v[48:51], v[224:227], v[96:99], 0
  v_add_u32 v1, 2048, v1
  buffer_load_dwordx4 v[160:163], v1, s[12:15], s16 offen sc1
  v_add_u32 v2, 2048, v2
  buffer_load_dwordx4 v[164:167], v2, s[12:15], s16 offen sc1
  ds_read_b64_tr_b16 v[248:249], v8 offset:20576
  ds_read_b64_tr_b16 v[250:251], v8 offset:21856
  v_mfma_f32_16x16x32_bf16 v[72:75], v[228:231], v[100:103], 0
  v_mfma_f32_16x16x32_bf16 v[188:191], v[228:231], v[104:107], 0
  v_add_u32 v5, 2048, v5
  buffer_load_dwordx4 v[168:171], v5, s[12:15], s16 offen sc1
  v_add_u32 v6, 2048, v6
  buffer_load_dwordx4 v[172:175], v6, s[12:15], s16 offen sc1
  v_mfma_f32_16x16x32_bf16 v[208:211], v[228:231], v[108:111], 0
  v_mfma_f32_16x16x32_bf16 v[52:55], v[228:231], v[96:99], 0
  ds_read_b64_tr_b16 v[252:253], v8 offset:20608
  ds_read_b64_tr_b16 v[254:255], v8 offset:21888
  v_mfma_f32_16x16x32_bf16 v[76:79], v[232:235], v[100:103], 0
  v_mfma_f32_16x16x32_bf16 v[192:195], v[232:235], v[104:107], 0
  v_mfma_f32_16x16x32_bf16 v[212:215], v[232:235], v[108:111], 0
  v_mfma_f32_16x16x32_bf16 v[56:59], v[232:235], v[96:99], 0
  s_waitcnt lgkmcnt(0)
  s_setprio 0
  ds_read_b64_tr_b16 v[216:217], v8 offset:40960
  ds_read_b64_tr_b16 v[218:219], v8 offset:42240
  v_mfma_f32_16x16x32_bf16 v[60:63], v[236:239], v[116:119], v[60:63]
  v_mfma_f32_16x16x32_bf16 v[176:179], v[236:239], v[120:123], v[176:179]
  s_add_u32 m0, s74, 20480
  s_nop 0
  buffer_load_dwordx4 v7, s[12:15], s27 offen offset:0 sc1 lds
  v_mfma_f32_16x16x32_bf16 v[196:199], v[236:239], v[124:127], v[196:199]
  v_mfma_f32_16x16x32_bf16 v[40:43], v[236:239], v[112:115], v[40:43]
  buffer_load_dwordx4 v7, s[12:15], s27 offen offset:1024 sc1 lds
  ds_read_b64_tr_b16 v[220:221], v8 offset:40992
  ds_read_b64_tr_b16 v[222:223], v8 offset:42272
  v_mfma_f32_16x16x32_bf16 v[64:67], v[240:243], v[116:119], v[64:67]
  v_mfma_f32_16x16x32_bf16 v[180:183], v[240:243], v[120:123], v[180:183]
  buffer_load_dwordx4 v7, s[12:15], s27 offen offset:2048 sc1 lds
  v_mfma_f32_16x16x32_bf16 v[200:203], v[240:243], v[124:127], v[200:203]
  v_mfma_f32_16x16x32_bf16 v[44:47], v[240:243], v[112:115], v[44:47]
  buffer_load_dwordx4 v7, s[12:15], s27 offen offset:3072 sc1 lds
  ds_read_b64_tr_b16 v[224:225], v8 offset:41024
  ds_read_b64_tr_b16 v[226:227], v8 offset:42304
  v_mfma_f32_16x16x32_bf16 v[68:71], v[244:247], v[116:119], v[68:71]
  v_mfma_f32_16x16x32_bf16 v[184:187], v[244:247], v[120:123], v[184:187]
  s_add_u32 m0, s74, 24576
  s_add_u32 s70, s27, 4096
  buffer_load_dwordx4 v7, s[12:15], s70 offen offset:0 sc1 lds
  v_mfma_f32_16x16x32_bf16 v[204:207], v[244:247], v[124:127], v[204:207]
  v_mfma_f32_16x16x32_bf16 v[48:51], v[244:247], v[112:115], v[48:51]
  buffer_load_dwordx4 v[96:99], v1, s[12:15], s17 offen sc1
  buffer_load_dwordx4 v[100:103], v2, s[12:15], s17 offen sc1
  ds_read_b64_tr_b16 v[228:229], v8 offset:41056
  ds_read_b64_tr_b16 v[230:231], v8 offset:42336
  v_mfma_f32_16x16x32_bf16 v[72:75], v[248:251], v[116:119], v[72:75]
  v_mfma_f32_16x16x32_bf16 v[188:191], v[248:251], v[120:123], v[188:191]
  buffer_load_dwordx4 v[104:107], v5, s[12:15], s17 offen sc1
  buffer_load_dwordx4 v[108:111], v6, s[12:15], s17 offen sc1
  v_mfma_f32_16x16x32_bf16 v[208:211], v[248:251], v[124:127], v[208:211]
  v_mfma_f32_16x16x32_bf16 v[52:55], v[248:251], v[112:115], v[52:55]
  ds_read_b64_tr_b16 v[232:233], v8 offset:41088
  ds_read_b64_tr_b16 v[234:235], v8 offset:42368
  v_mfma_f32_16x16x32_bf16 v[76:79], v[252:255], v[116:119], v[76:79]
  v_mfma_f32_16x16x32_bf16 v[192:195], v[252:255], v[120:123], v[192:195]
  v_mfma_f32_16x16x32_bf16 v[212:215], v[252:255], v[124:127], v[212:215]
  v_mfma_f32_16x16x32_bf16 v[56:59], v[252:255], v[112:115], v[56:59]
  s_waitcnt lgkmcnt(0)
  ds_read_b64_tr_b16 v[236:237], v8 offset:61440
  ds_read_b64_tr_b16 v[238:239], v8 offset:62720
  v_mfma_f32_16x16x32_bf16 v[60:63], v[216:219], v[132:135], v[60:63]
  v_mfma_f32_16x16x32_bf16 v[176:179], v[216:219], v[136:139], v[176:179]
  s_add_u32 m0, s74, 40960
  s_nop 0
  buffer_load_dwordx4 v7, s[12:15], s28 offen offset:0 sc1 lds
  v_mfma_f32_16x16x32_bf16 v[196:199], v[216:219], v[140:143], v[196:199]
  v_mfma_f32_16x16x32_bf16 v[40:43], v[216:219], v[128:131], v[40:43]
  buffer_load_dwordx4 v7, s[12:15], s28 offen offset:1024 sc1 lds
  ds_read_b64_tr_b16 v[240:241], v8 offset:61472
  ds_read_b64_tr_b16 v[242:243], v8 offset:62752
  v_mfma_f32_16x16x32_bf16 v[64:67], v[220:223], v[132:135], v[64:67]
  v_mfma_f32_16x16x32_bf16 v[180:183], v[220:223], v[136:139], v[180:183]
  buffer_load_dwordx4 v7, s[12:15], s28 offen offset:2048 sc1 lds
  v_mfma_f32_16x16x32_bf16 v[200:203], v[220:223], v[140:143], v[200:203]
  v_mfma_f32_16x16x32_bf16 v[44:47], v[220:223], v[128:131], v[44:47]
  buffer_load_dwordx4 v7, s[12:15], s28 offen offset:3072 sc1 lds
  ds_read_b64_tr_b16 v[244:245], v8 offset:61504
  ds_read_b64_tr_b16 v[246:247], v8 offset:62784
  v_mfma_f32_16x16x32_bf16 v[68:71], v[224:227], v[132:135], v[68:71]
  v_mfma_f32_16x16x32_bf16 v[184:187], v[224:227], v[136:139], v[184:187]
  s_add_u32 m0, s74, 45056
  s_add_u32 s70, s28, 4096
  buffer_load_dwordx4 v7, s[12:15], s70 offen offset:0 sc1 lds
  v_mfma_f32_16x16x32_bf16 v[204:207], v[224:227], v[140:143], v[204:207]
  v_mfma_f32_16x16x32_bf16 v[48:51], v[224:227], v[128:131], v[48:51]
  buffer_load_dwordx4 v[112:115], v1, s[12:15], s18 offen sc1
  buffer_load_dwordx4 v[116:119], v2, s[12:15], s18 offen sc1
  ds_read_b64_tr_b16 v[248:249], v8 offset:61536
  ds_read_b64_tr_b16 v[250:251], v8 offset:62816
  v_mfma_f32_16x16x32_bf16 v[72:75], v[228:231], v[132:135], v[72:75]
  v_mfma_f32_16x16x32_bf16 v[188:191], v[228:231], v[136:139], v[188:191]
  buffer_load_dwordx4 v[120:123], v5, s[12:15], s18 offen sc1
  buffer_load_dwordx4 v[124:127], v6, s[12:15], s18 offen sc1
  v_mfma_f32_16x16x32_bf16 v[208:211], v[228:231], v[140:143], v[208:211]
  v_mfma_f32_16x16x32_bf16 v[52:55], v[228:231], v[128:131], v[52:55]
  ds_read_b64_tr_b16 v[252:253], v8 offset:61568
  ds_read_b64_tr_b16 v[254:255], v8 offset:62848
  v_mfma_f32_16x16x32_bf16 v[76:79], v[232:235], v[132:135], v[76:79]
  v_mfma_f32_16x16x32_bf16 v[192:195], v[232:235], v[136:139], v[192:195]
  v_mfma_f32_16x16x32_bf16 v[212:215], v[232:235], v[140:143], v[212:215]
  v_mfma_f32_16x16x32_bf16 v[56:59], v[232:235], v[128:131], v[56:59]
  buffer_load_dwordx2 v[22:23], v3, s[4:7], 0 offen offset:0
  buffer_load_dwordx2 v[24:25], v3, s[4:7], 0 offen offset:32
  buffer_load_dwordx2 v[26:27], v3, s[4:7], 0 offen offset:64
  buffer_load_dwordx2 v[28:29], v3, s[4:7], 0 offen offset:96
  buffer_load_dwordx2 v[30:31], v3, s[4:7], 0 offen offset:128
  s_waitcnt vmcnt(23) lgkmcnt(0)
  ds_read_b64_tr_b16 v[216:217], v8 offset:0
  ds_read_b64_tr_b16 v[218:219], v8 offset:1280
  v_mfma_f32_16x16x32_bf16 v[60:63], v[236:239], v[148:151], v[60:63]
  v_mfma_f32_16x16x32_bf16 v[176:179], v[236:239], v[152:155], v[176:179]
  s_add_u32 m0, s74, 61440
  s_nop 0
  buffer_load_dwordx4 v7, s[12:15], s29 offen offset:0 sc1 lds
  v_mfma_f32_16x16x32_bf16 v[196:199], v[236:239], v[156:159], v[196:199]
  v_mfma_f32_16x16x32_bf16 v[40:43], v[236:239], v[144:147], v[40:43]
  buffer_load_dwordx4 v7, s[12:15], s29 offen offset:1024 sc1 lds
  ds_read_b64_tr_b16 v[220:221], v8 offset:32
  ds_read_b64_tr_b16 v[222:223], v8 offset:1312
  v_mfma_f32_16x16x32_bf16 v[64:67], v[240:243], v[148:151], v[64:67]
  v_mfma_f32_16x16x32_bf16 v[180:183], v[240:243], v[152:155], v[180:183]
  buffer_load_dwordx4 v7, s[12:15], s29 offen offset:2048 sc1 lds
  v_mfma_f32_16x16x32_bf16 v[200:203], v[240:243], v[156:159], v[200:203]
  v_mfma_f32_16x16x32_bf16 v[44:47], v[240:243], v[144:147], v[44:47]
  buffer_load_dwordx4 v7, s[12:15], s29 offen offset:3072 sc1 lds
  ds_read_b64_tr_b16 v[224:225], v8 offset:64
  ds_read_b64_tr_b16 v[226:227], v8 offset:1344
  v_mfma_f32_16x16x32_bf16 v[68:71], v[244:247], v[148:151], v[68:71]
  v_mfma_f32_16x16x32_bf16 v[184:187], v[244:247], v[152:155], v[184:187]
  s_add_u32 m0, s74, 65536
  s_add_u32 s70, s29, 4096
  buffer_load_dwordx4 v7, s[12:15], s70 offen offset:0 sc1 lds
  v_mfma_f32_16x16x32_bf16 v[204:207], v[244:247], v[156:159], v[204:207]
  v_mfma_f32_16x16x32_bf16 v[48:51], v[244:247], v[144:147], v[48:51]
  buffer_load_dwordx4 v[128:131], v1, s[12:15], s19 offen sc1
  buffer_load_dwordx4 v[132:135], v2, s[12:15], s19 offen sc1
  ds_read_b64_tr_b16 v[228:229], v8 offset:96
  ds_read_b64_tr_b16 v[230:231], v8 offset:1376
  v_mfma_f32_16x16x32_bf16 v[72:75], v[248:251], v[148:151], v[72:75]
  v_mfma_f32_16x16x32_bf16 v[188:191], v[248:251], v[152:155], v[188:191]
  buffer_load_dwordx4 v[136:139], v5, s[12:15], s19 offen sc1
  buffer_load_dwordx4 v[140:143], v6, s[12:15], s19 offen sc1
  v_mfma_f32_16x16x32_bf16 v[208:211], v[248:251], v[156:159], v[208:211]
  v_mfma_f32_16x16x32_bf16 v[52:55], v[248:251], v[144:147], v[52:55]
  ds_read_b64_tr_b16 v[232:233], v8 offset:128
  ds_read_b64_tr_b16 v[234:235], v8 offset:1408
  v_mfma_f32_16x16x32_bf16 v[76:79], v[252:255], v[148:151], v[76:79]
  v_mfma_f32_16x16x32_bf16 v[192:195], v[252:255], v[152:155], v[192:195]
  v_mfma_f32_16x16x32_bf16 v[212:215], v[252:255], v[156:159], v[212:215]
  v_mfma_f32_16x16x32_bf16 v[56:59], v[252:255], v[144:147], v[56:59]
  buffer_load_dword v10, v4, s[12:15], s80 offen sc1
  s_waitcnt vmcnt(24) lgkmcnt(0)
  ds_read_b64_tr_b16 v[236:237], v8 offset:20480
  ds_read_b64_tr_b16 v[238:239], v8 offset:21760
  v_mfma_f32_16x16x32_bf16 v[60:63], v[216:219], v[164:167], v[60:63]
  v_mfma_f32_16x16x32_bf16 v[176:179], v[216:219], v[168:171], v[176:179]
  s_add_u32 m0, s74, 0
  v_add_u32 v7, 10240, v7
  buffer_load_dwordx4 v7, s[12:15], s26 offen offset:0 sc1 lds
  v_mfma_f32_16x16x32_bf16 v[196:199], v[216:219], v[172:175], v[196:199]
  v_mfma_f32_16x16x32_bf16 v[40:43], v[216:219], v[160:163], v[40:43]
  buffer_load_dwordx4 v7, s[12:15], s26 offen offset:1024 sc1 lds
  ds_read_b64_tr_b16 v[240:241], v8 offset:20512
  ds_read_b64_tr_b16 v[242:243], v8 offset:21792
  v_mfma_f32_16x16x32_bf16 v[64:67], v[220:223], v[164:167], v[64:67]
  v_mfma_f32_16x16x32_bf16 v[180:183], v[220:223], v[168:171], v[180:183]
  buffer_load_dwordx4 v7, s[12:15], s26 offen offset:2048 sc1 lds
  v_mfma_f32_16x16x32_bf16 v[200:203], v[220:223], v[172:175], v[200:203]
  v_mfma_f32_16x16x32_bf16 v[44:47], v[220:223], v[160:163], v[44:47]
  buffer_load_dwordx4 v7, s[12:15], s26 offen offset:3072 sc1 lds
  ds_read_b64_tr_b16 v[244:245], v8 offset:20544
  ds_read_b64_tr_b16 v[246:247], v8 offset:21824
  v_mfma_f32_16x16x32_bf16 v[68:71], v[224:227], v[164:167], v[68:71]
  v_mfma_f32_16x16x32_bf16 v[184:187], v[224:227], v[168:171], v[184:187]
  s_add_u32 m0, s74, 4096
  s_add_u32 s70, s26, 4096
  buffer_load_dwordx4 v7, s[12:15], s70 offen offset:0 sc1 lds
  v_mfma_f32_16x16x32_bf16 v[204:207], v[224:227], v[172:175], v[204:207]
  v_mfma_f32_16x16x32_bf16 v[48:51], v[224:227], v[160:163], v[48:51]
  ds_read_b64_tr_b16 v[248:249], v8 offset:20576
  ds_read_b64_tr_b16 v[250:251], v8 offset:21856
  v_mfma_f32_16x16x32_bf16 v[72:75], v[228:231], v[164:167], v[72:75]
  v_mfma_f32_16x16x32_bf16 v[188:191], v[228:231], v[168:171], v[188:191]
  v_mfma_f32_16x16x32_bf16 v[208:211], v[228:231], v[172:175], v[208:211]
  v_mfma_f32_16x16x32_bf16 v[52:55], v[228:231], v[160:163], v[52:55]
  ds_read_b64_tr_b16 v[252:253], v8 offset:20608
  ds_read_b64_tr_b16 v[254:255], v8 offset:21888
  v_mfma_f32_16x16x32_bf16 v[76:79], v[232:235], v[164:167], v[76:79]
  v_mfma_f32_16x16x32_bf16 v[192:195], v[232:235], v[168:171], v[192:195]
  v_mfma_f32_16x16x32_bf16 v[212:215], v[232:235], v[172:175], v[212:215]
  v_mfma_f32_16x16x32_bf16 v[56:59], v[232:235], v[160:163], v[56:59]
  s_waitcnt vmcnt(5)
  v_cmp_ne_u32 vcc, s52, v10
  s_nop 0
  s_cmp_eq_u64 vcc, 0
  s_cbranch_scc1 Lok_14
  s_mov_b32 s60, 20000
Lspin_13:
  s_sleep 4
  buffer_load_dword v10, v4, s[12:15], s80 offen sc1
  s_waitcnt vmcnt(0)
  v_cmp_ne_u32 vcc, s52, v10
  s_nop 0
  s_cmp_eq_u64 vcc, 0
  s_cbranch_scc1 Lok_14
  s_sub_u32 s60, s60, 1
  s_cmp_lg_u32 s60, 0
  s_cbranch_scc1 Lspin_13
Lok_14:
  s_waitcnt lgkmcnt(0)
  ds_read_b64_tr_b16 v[216:217], v8 offset:40960
  ds_read_b64_tr_b16 v[218:219], v8 offset:42240
  v_mfma_f32_16x16x32_bf16 v[60:63], v[236:239], v[100:103], v[60:63]
  v_mfma_f32_16x16x32_bf16 v[176:179], v[236:239], v[104:107], v[176:179]
  s_add_u32 m0, s74, 20480
  s_nop 0
  buffer_load_dwordx4 v7, s[12:15], s27 offen offset:0 sc1 lds
  v_mfma_f32_16x16x32_bf16 v[196:199], v[236:239], v[108:111], v[196:199]
  v_mfma_f32_16x16x32_bf16 v[40:43], v[236:239], v[96:99], v[40:43]
  buffer_load_dwordx4 v7, s[12:15], s27 offen offset:1024 sc1 lds
  ds_read_b64_tr_b16 v[220:221], v8 offset:40992
  ds_read_b64_tr_b16 v[222:223], v8 offset:42272
  v_mfma_f32_16x16x32_bf16 v[64:67], v[240:243], v[100:103], v[64:67]
  v_mfma_f32_16x16x32_bf16 v[180:183], v[240:243], v[104:107], v[180:183]
  buffer_load_dwordx4 v7, s[12:15], s27 offen offset:2048 sc1 lds
  v_mfma_f32_16x16x32_bf16 v[200:203], v[240:243], v[108:111], v[200:203]
  v_mfma_f32_16x16x32_bf16 v[44:47], v[240:243], v[96:99], v[44:47]
  buffer_load_dwordx4 v7, s[12:15], s27 offen offset:3072 sc1 lds
  ds_read_b64_tr_b16 v[224:225], v8 offset:41024
  ds_read_b64_tr_b16 v[226:227], v8 offset:42304
  v_mfma_f32_16x16x32_bf16 v[68:71], v[244:247], v[100:103], v[68:71]
  v_mfma_f32_16x16x32_bf16 v[184:187], v[244:247], v[104:107], v[184:187]
  s_add_u32 m0, s74, 24576
  s_add_u32 s70, s27, 4096
  buffer_load_dwordx4 v7, s[12:15], s70 offen offset:0 sc1 lds
  v_mfma_f32_16x16x32_bf16 v[204:207], v[244:247], v[108:111], v[204:207]
  v_mfma_f32_16x16x32_bf16 v[48:51], v[244:247], v[96:99], v[48:51]
  v_add_u32 v1, 2048, v1
  buffer_load_dwordx4 v[144:147], v1, s[12:15], s16 offen sc1
  v_add_u32 v2, 2048, v2
  buffer_load_dwordx4 v[148:151], v2, s[12:15], s16 offen sc1
  ds_read_b64_tr_b16 v[228:229], v8 offset:41056
  ds_read_b64_tr_b16 v[230:231], v8 offset:42336
  v_mfma_f32_16x16x32_bf16 v[72:75], v[248:251], v[100:103], v[72:75]
  v_mfma_f32_16x16x32_bf16 v[188:191], v[248:251], v[104:107], v[188:191]
  v_add_u32 v5, 2048, v5
  buffer_load_dwordx4 v[152:155], v5, s[12:15], s16 offen sc1
  v_add_u32 v6, 2048, v6
  buffer_load_dwordx4 v[156:159], v6, s[12:15], s16 offen sc1
  v_mfma_f32_16x16x32_bf16 v[208:211], v[248:251], v[108:111], v[208:211]
  v_mfma_f32_16x16x32_bf16 v[52:55], v[248:251], v[96:99], v[52:55]
  buffer_load_dwordx4 v[160:163], v1, s[12:15], s17 offen sc1
  buffer_load_dwordx4 v[164:167], v2, s[12:15], s17 offen sc1
  ds_read_b64_tr_b16 v[232:233], v8 offset:41088
  ds_read_b64_tr_b16 v[234:235], v8 offset:42368
  v_mfma_f32_16x16x32_bf16 v[76:79], v[252:255], v[100:103], v[76:79]
  v_mfma_f32_16x16x32_bf16 v[192:195], v[252:255], v[104:107], v[192:195]
  buffer_load_dwordx4 v[168:171], v5, s[12:15], s17 offen sc1
  buffer_load_dwordx4 v[172:175], v6, s[12:15], s17 offen sc1
  v_mfma_f32_16x16x32_bf16 v[212:215], v[252:255], v[108:111], v[212:215]
  v_mfma_f32_16x16x32_bf16 v[56:59], v[252:255], v[96:99], v[56:59]
  s_waitcnt lgkmcnt(0)
  ds_read_b64_tr_b16 v[236:237], v8 offset:61440
  ds_read_b64_tr_b16 v[238:239], v8 offset:62720
  v_mfma_f32_16x16x32_bf16 v[60:63], v[216:219], v[116:119], v[60:63]
  v_mfma_f32_16x16x32_bf16 v[176:179], v[216:219], v[120:123], v[176:179]
  s_add_u32 m0, s74, 40960
  s_nop 0
  buffer_load_dwordx4 v7, s[12:15], s28 offen offset:0 sc1 lds
  v_mfma_f32_16x16x32_bf16 v[196:199], v[216:219], v[124:127], v[196:199]
  v_mfma_f32_16x16x32_bf16 v[40:43], v[216:219], v[112:115], v[40:43]
  buffer_load_dwordx4 v7, s[12:15], s28 offen offset:1024 sc1 lds
  ds_read_b64_tr_b16 v[240:241], v8 offset:61472
  ds_read_b64_tr_b16 v[242:243], v8 offset:62752
  v_mfma_f32_16x16x32_bf16 v[64:67], v[220:223], v[116:119], v[64:67]
  v_mfma_f32_16x16x32_bf16 v[180:183], v[220:223], v[120:123], v[180:183]
  buffer_load_dwordx4 v7, s[12:15], s28 offen offset:2048 sc1 lds
  v_mfma_f32_16x16x32_bf16 v[200:203], v[220:223], v[124:127], v[200:203]
  v_mfma_f32_16x16x32_bf16 v[44:47], v[220:223], v[112:115], v[44:47]
  buffer_load_dwordx4 v7, s[12:15], s28 offen offset:3072 sc1 lds
  ds_read_b64_tr_b16 v[244:245], v8 offset:61504
  ds_read_b64_tr_b16 v[246:247], v8 offset:62784
  v_mfma_f32_16x16x32_bf16 v[68:71], v[224:227], v[116:119], v[68:71]
  v_mfma_f32_16x16x32_bf16 v[184:187], v[224:227], v[120:123], v[184:187]
  s_add_u32 m0, s74, 45056
  s_add_u32 s70, s28, 4096
  buffer_load_dwordx4 v7, s[12:15], s70 offen offset:0 sc1 lds
  v_mfma_f32_16x16x32_bf16 v[204:207], v[224:227], v[124:127], v[204:207]
  v_mfma_f32_16x16x32_bf16 v[48:51], v[224:227], v[112:115], v[48:51]
  buffer_load_dwordx4 v[96:99], v1, s[12:15], s18 offen sc1
  buffer_load_dwordx4 v[100:103], v2, s[12:15], s18 offen sc1
  ds_read_b64_tr_b16 v[248:249], v8 offset:61536
  ds_read_b64_tr_b16 v[250:251], v8 offset:62816
  v_mfma_f32_16x16x32_bf16 v[72:75], v[228:231], v[116:119], v[72:75]
  v_mfma_f32_16x16x32_bf16 v[188:191], v[228:231], v[120:123], v[188:191]
  buffer_load_dwordx4 v[104:107], v5, s[12:15], s18 offen sc1
  buffer_load_dwordx4 v[108:111], v6, s[12:15], s18 offen sc1
  v_mfma_f32_16x16x32_bf16 v[208:211], v[228:231], v[124:127], v[208:211]
  v_mfma_f32_16x16x32_bf16 v[52:55], v[228:231], v[112:115], v[52:55]
  ds_read_b64_tr_b16 v[252:253], v8 offset:61568
  ds_read_b64_tr_b16 v[254:255], v8 offset:62848
  v_mfma_f32_16x16x32_bf16 v[76:79], v[232:235], v[116:119], v[76:79]
  v_mfma_f32_16x16x32_bf16 v[192:195], v[232:235], v[120:123], v[192:195]
  v_mfma_f32_16x16x32_bf16 v[212:215], v[232:235], v[124:127], v[212:215]
  v_mfma_f32_16x16x32_bf16 v[56:59], v[232:235], v[112:115], v[56:59]
  s_lshl_b32 s75, s55, 12
  s_add_u32 s75, s75, 65536
  s_mul_i32 s70, s55, 80
  v_lshrrev_b32 v33, 1, v0
  v_add_u32 v33, s70, v33
  v_lshlrev_b32 v33, 12, v33
  v_and_b32 v34, 1, v0
  v_lshl_add_u32 v33, v34, 4, v33
  v_add_u32 v34, 130048, v33
  v_add_u32 v35, 260096, v33
  s_lshl_b32 s76, s54, 7
  s_lshl_b32 s70, s3, 5
  s_add_u32 s76, s76, s70
  s_add_u32 s76, s76, 4194304
  v_lshlrev_b32 v80, 3, v0
  v_add_u32 v80, s74, v80
  v_lshlrev_b32 v36, 4, v0
  v_add_u32 v36, 4096, v36
  v_add_u32 v37, s74, v36
  s_sub_u32 s70, s3, 1
  s_and_b32 s70, s70, 3
  s_mul_i32 s70, s70, 5120
  v_add_u32 v85, s70, v36
  s_sub_u32 s70, s3, 2
  s_and_b32 s70, s70, 3
  s_mul_i32 s70, s70, 5120
  v_add_u32 v86, s70, v36
  s_sub_u32 s70, s3, 3
  s_and_b32 s70, s70, 3
  s_mul_i32 s70, s70, 5120
  v_add_u32 v87, s70, v36
  s_waitcnt vmcnt(13) lgkmcnt(0)
  ds_read_b64_tr_b16 v[216:217], v8 offset:0
  ds_read_b64_tr_b16 v[218:219], v8 offset:1280
  v_mfma_f32_16x16x32_bf16 v[60:63], v[236:239], v[132:135], v[60:63]
  v_mfma_f32_16x16x32_bf16 v[176:179], v[236:239], v[136:139], v[176:179]
  s_add_u32 m0, s74, 61440
  s_nop 0
  buffer_load_dwordx4 v7, s[12:15], s29 offen offset:0 sc1 lds
  v_mfma_f32_16x16x32_bf16 v[196:199], v[236:239], v[140:143], v[196:199]
  v_mfma_f32_16x16x32_bf16 v[40:43], v[236:239], v[128:131], v[40:43]
  buffer_load_dwordx4 v7, s[12:15], s29 offen offset:1024 sc1 lds
  ds_read_b64_tr_b16 v[220:221], v8 offset:32
  ds_read_b64_tr_b16 v[222:223], v8 offset:1312
  v_mfma_f32_16x16x32_bf16 v[64:67], v[240:243], v[132:135], v[64:67]
  v_mfma_f32_16x16x32_bf16 v[180:183], v[240:243], v[136:139], v[180:183]
  buffer_load_dwordx4 v7, s[12:15], s29 offen offset:2048 sc1 lds
  v_mfma_f32_16x16x32_bf16 v[200:203], v[240:243], v[140:143], v[200:203]
  v_mfma_f32_16x16x32_bf16 v[44:47], v[240:243], v[128:131], v[44:47]
  buffer_load_dwordx4 v7, s[12:15], s29 offen offset:3072 sc1 lds
  ds_read_b64_tr_b16 v[224:225], v8 offset:64
  ds_read_b64_tr_b16 v[226:227], v8 offset:1344
  v_mfma_f32_16x16x32_bf16 v[68:71], v[244:247], v[132:135], v[68:71]
  v_mfma_f32_16x16x32_bf16 v[184:187], v[244:247], v[136:139], v[184:187]
  s_add_u32 m0, s74, 65536
  s_add_u32 s70, s29, 4096
  buffer_load_dwordx4 v7, s[12:15], s70 offen offset:0 sc1 lds
  v_mfma_f32_16x16x32_bf16 v[204:207], v[244:247], v[140:143], v[204:207]
  v_mfma_f32_16x16x32_bf16 v[48:51], v[244:247], v[128:131], v[48:51]
  buffer_load_dwordx4 v[112:115], v1, s[12:15], s19 offen sc1
  buffer_load_dwordx4 v[116:119], v2, s[12:15], s19 offen sc1
  ds_read_b64_tr_b16 v[228:229], v8 offset:96
  ds_read_b64_tr_b16 v[230:231], v8 offset:1376
  v_mfma_f32_16x16x32_bf16 v[72:75], v[248:251], v[132:135], v[72:75]
  v_mfma_f32_16x16x32_bf16 v[188:191], v[248:251], v[136:139], v[188:191]
  buffer_load_dwordx4 v[120:123], v5, s[12:15], s19 offen sc1
  buffer_load_dwordx4 v[124:127], v6, s[12:15], s19 offen sc1
  v_mfma_f32_16x16x32_bf16 v[208:211], v[248:251], v[140:143], v[208:211]
  v_mfma_f32_16x16x32_bf16 v[52:55], v[248:251], v[128:131], v[52:55]
  ds_read_b64_tr_b16 v[232:233], v8 offset:128
  ds_read_b64_tr_b16 v[234:235], v8 offset:1408
  v_mfma_f32_16x16x32_bf16 v[76:79], v[252:255], v[132:135], v[76:79]
  v_mfma_f32_16x16x32_bf16 v[192:195], v[252:255], v[136:139], v[192:195]
  v_mfma_f32_16x16x32_bf16 v[212:215], v[252:255], v[140:143], v[212:215]
  v_mfma_f32_16x16x32_bf16 v[56:59], v[252:255], v[128:131], v[56:59]
  buffer_load_dword v32, v4, s[12:15], s75 offen sc1
  s_waitcnt vmcnt(19) lgkmcnt(0)
  ds_read_b64_tr_b16 v[236:237], v8 offset:20480
  ds_read_b64_tr_b16 v[238:239], v8 offset:21760
  v_mfma_f32_16x16x32_bf16 v[60:63], v[216:219], v[148:151], v[60:63]
  v_mfma_f32_16x16x32_bf16 v[176:179], v[216:219], v[152:155], v[176:179]
  v_mfma_f32_16x16x32_bf16 v[196:199], v[216:219], v[156:159], v[196:199]
  v_mfma_f32_16x16x32_bf16 v[40:43], v[216:219], v[144:147], v[40:43]
  ds_read_b64_tr_b16 v[240:241], v8 offset:20512
  ds_read_b64_tr_b16 v[242:243], v8 offset:21792
  v_mfma_f32_16x16x32_bf16 v[64:67], v[220:223], v[148:151], v[64:67]
  v_mfma_f32_16x16x32_bf16 v[180:183], v[220:223], v[152:155], v[180:183]
  v_mfma_f32_16x16x32_bf16 v[200:203], v[220:223], v[156:159], v[200:203]
  v_mfma_f32_16x16x32_bf16 v[44:47], v[220:223], v[144:147], v[44:47]
  ds_read_b64_tr_b16 v[244:245], v8 offset:20544
  ds_read_b64_tr_b16 v[246:247], v8 offset:21824
  v_mfma_f32_16x16x32_bf16 v[68:71], v[224:227], v[148:151], v[68:71]
  v_mfma_f32_16x16x32_bf16 v[184:187], v[224:227], v[152:155], v[184:187]
  v_mfma_f32_16x16x32_bf16 v[204:207], v[224:227], v[156:159], v[204:207]
  v_mfma_f32_16x16x32_bf16 v[48:51], v[224:227], v[144:147], v[48:51]
  ds_read_b64_tr_b16 v[248:249], v8 offset:20576
  ds_read_b64_tr_b16 v[250:251], v8 offset:21856
  v_mfma_f32_16x16x32_bf16 v[72:75], v[228:231], v[148:151], v[72:75]
  v_mfma_f32_16x16x32_bf16 v[188:191], v[228:231], v[152:155], v[188:191]
  v_mfma_f32_16x16x32_bf16 v[208:211], v[228:231], v[156:159], v[208:211]
  v_mfma_f32_16x16x32_bf16 v[52:55], v[228:231], v[144:147], v[52:55]
  ds_read_b64_tr_b16 v[252:253], v8 offset:20608
  ds_read_b64_tr_b16 v[254:255], v8 offset:21888
  v_mfma_f32_16x16x32_bf16 v[76:79], v[232:235], v[148:151], v[76:79]
  v_mfma_f32_16x16x32_bf16 v[192:195], v[232:235], v[152:155], v[192:195]
  v_mfma_f32_16x16x32_bf16 v[212:215], v[232:235], v[156:159], v[212:215]
  v_mfma_f32_16x16x32_bf16 v[56:59], v[232:235], v[144:147], v[56:59]
  s_waitcnt vmcnt(10) lgkmcnt(0)
  ds_read_b64_tr_b16 v[216:217], v8 offset:40960
  ds_read_b64_tr_b16 v[218:219], v8 offset:42240
  v_mfma_f32_16x16x32_bf16 v[60:63], v[236:239], v[164:167], v[60:63]
  v_mfma_f32_16x16x32_bf16 v[176:179], v[236:239], v[168:171], v[176:179]
  v_mfma_f32_16x16x32_bf16 v[196:199], v[236:239], v[172:175], v[196:199]
  v_mfma_f32_16x16x32_bf16 v[40:43], v[236:239], v[160:163], v[40:43]
  ds_read_b64_tr_b16 v[220:221], v8 offset:40992
  ds_read_b64_tr_b16 v[222:223], v8 offset:42272
  v_mfma_f32_16x16x32_bf16 v[64:67], v[240:243], v[164:167], v[64:67]
  v_mfma_f32_16x16x32_bf16 v[180:183], v[240:243], v[168:171], v[180:183]
  v_mfma_f32_16x16x32_bf16 v[200:203], v[240:243], v[172:175], v[200:203]
  v_mfma_f32_16x16x32_bf16 v[44:47], v[240:243], v[160:163], v[44:47]
  ds_read_b64_tr_b16 v[224:225], v8 offset:41024
  ds_read_b64_tr_b16 v[226:227], v8 offset:42304
  v_mfma_f32_16x16x32_bf16 v[68:71], v[244:247], v[164:167], v[68:71]
  v_mfma_f32_16x16x32_bf16 v[184:187], v[244:247], v[168:171], v[184:187]
  v_mfma_f32_16x16x32_bf16 v[204:207], v[244:247], v[172:175], v[204:207]
  v_mfma_f32_16x16x32_bf16 v[48:51], v[244:247], v[160:163], v[48:51]
  ds_read_b64_tr_b16 v[228:229], v8 offset:41056
  ds_read_b64_tr_b16 v[230:231], v8 offset:42336
  v_mfma_f32_16x16x32_bf16 v[72:75], v[248:251], v[164:167], v[72:75]
  v_mfma_f32_16x16x32_bf16 v[188:191], v[248:251], v[168:171], v[188:191]
  v_mfma_f32_16x16x32_bf16 v[208:211], v[248:251], v[172:175], v[208:211]
  v_mfma_f32_16x16x32_bf16 v[52:55], v[248:251], v[160:163], v[52:55]
  ds_read_b64_tr_b16 v[232:233], v8 offset:41088
  ds_read_b64_tr_b16 v[234:235], v8 offset:42368
  v_mfma_f32_16x16x32_bf16 v[76:79], v[252:255], v[164:167], v[76:79]
  v_mfma_f32_16x16x32_bf16 v[192:195], v[252:255], v[168:171], v[192:195]
  v_mfma_f32_16x16x32_bf16 v[212:215], v[252:255], v[172:175], v[212:215]
  v_mfma_f32_16x16x32_bf16 v[56:59], v[252:255], v[160:163], v[56:59]
  s_waitcnt vmcnt(0)
  v_cmp_ne_u32 vcc, s52, v32
  s_nop 0
  s_cmp_eq_u64 vcc, 0
  s_cselect_b32 s77, 1, 0
  s_mov_b32 m0, s74
  s_nop 0
  buffer_load_dwordx4 v33, s[12:15], s76 offen sc1 lds
  buffer_load_dwordx4 v34, s[12:15], s76 offen offset:1024 sc1 lds
  s_mov_b64 exec, 0xffffffff
  buffer_load_dwordx4 v35, s[12:15], s76 offen offset:2048 sc1 lds
  s_mov_b64 exec, -1
  s_waitcnt lgkmcnt(0)
  ds_read_b64_tr_b16 v[236:237], v8 offset:61440
  ds_read_b64_tr_b16 v[238:239], v8 offset:62720
  v_mfma_f32_16x16x32_bf16 v[60:63], v[216:219], v[100:103], v[60:63]
  v_mfma_f32_16x16x32_bf16 v[176:179], v[216:219], v[104:107], v[176:179]
  v_mfma_f32_16x16x32_bf16 v[196:199], v[216:219], v[108:111], v[196:199]
  v_mfma_f32_16x16x32_bf16 v[40:43], v[216:219], v[96:99], v[40:43]
  ds_read_b64_tr_b16 v[240:241], v8 offset:61472
  ds_read_b64_tr_b16 v[242:243], v8 offset:62752
  v_mfma_f32_16x16x32_bf16 v[64:67], v[220:223], v[100:103], v[64:67]
  v_mfma_f32_16x16x32_bf16 v[180:183], v[220:223], v[104:107], v[180:183]
  v_mfma_f32_16x16x32_bf16 v[200:203], v[220:223], v[108:111], v[200:203]
  v_mfma_f32_16x16x32_bf16 v[44:47], v[220:223], v[96:99], v[44:47]
  ds_read_b64_tr_b16 v[244:245], v8 offset:61504
  ds_read_b64_tr_b16 v[246:247], v8 offset:62784
  v_mfma_f32_16x16x32_bf16 v[68:71], v[224:227], v[100:103], v[68:71]
  v_mfma_f32_16x16x32_bf16 v[184:187], v[224:227], v[104:107], v[184:187]
  v_mfma_f32_16x16x32_bf16 v[204:207], v[224:227], v[108:111], v[204:207]
  v_mfma_f32_16x16x32_bf16 v[48:51], v[224:227], v[96:99], v[48:51]
  ds_read_b64_tr_b16 v[248:249], v8 offset:61536
  ds_read_b64_tr_b16 v[250:251], v8 offset:62816
  v_mfma_f32_16x16x32_bf16 v[72:75], v[228:231], v[100:103], v[72:75]
  v_mfma_f32_16x16x32_bf16 v[188:191], v[228:231], v[104:107], v[188:191]
  v_mfma_f32_16x16x32_bf16 v[208:211], v[228:231], v[108:111], v[208:211]
  v_mfma_f32_16x16x32_bf16 v[52:55], v[228:231], v[96:99], v[52:55]
  ds_read_b64_tr_b16 v[252:253], v8 offset:61568
  ds_read_b64_tr_b16 v[254:255], v8 offset:62848
  v_mfma_f32_16x16x32_bf16 v[76:79], v[232:235], v[100:103], v[76:79]
  v_mfma_f32_16x16x32_bf16 v[192:195], v[232:235], v[104:107], v[192:195]
  v_mfma_f32_16x16x32_bf16 v[212:215], v[232:235], v[108:111], v[212:215]
  v_mfma_f32_16x16x32_bf16 v[56:59], v[232:235], v[96:99], v[56:59]
  s_waitcnt lgkmcnt(0)
  v_mfma_f32_16x16x32_bf16 v[60:63], v[236:239], v[116:119], v[60:63]
  v_mfma_f32_16x16x32_bf16 v[64:67], v[240:243], v[116:119], v[64:67]
  v_mfma_f32_16x16x32_bf16 v[68:71], v[244:247], v[116:119], v[68:71]
  v_mfma_f32_16x16x32_bf16 v[72:75], v[248:251], v[116:119], v[72:75]
  v_mfma_f32_16x16x32_bf16 v[76:79], v[252:255], v[116:119], v[76:79]
  v_mfma_f32_16x16x32_bf16 v[176:179], v[236:239], v[120:123], v[176:179]
  v_mfma_f32_16x16x32_bf16 v[180:183], v[240:243], v[120:123], v[180:183]
  v_mfma_f32_16x16x32_bf16 v[184:187], v[244:247], v[120:123], v[184:187]
  v_mfma_f32_16x16x32_bf16 v[188:191], v[248:251], v[120:123], v[188:191]
  v_mfma_f32_16x16x32_bf16 v[192:195], v[252:255], v[120:123], v[192:195]
  ds_write_b128 v37, v[60:63] offset:16384
  ds_write_b128 v37, v[64:67] offset:17408
  ds_write_b128 v37, v[68:71] offset:18432
  ds_write_b128 v37, v[72:75] offset:19456
  ds_write_b128 v37, v[76:79] offset:20480
  v_mfma_f32_16x16x32_bf16 v[196:199], v[236:239], v[124:127], v[196:199]
  v_mfma_f32_16x16x32_bf16 v[200:203], v[240:243], v[124:127], v[200:203]
  v_mfma_f32_16x16x32_bf16 v[204:207], v[244:247], v[124:127], v[204:207]
  v_mfma_f32_16x16x32_bf16 v[208:211], v[248:251], v[124:127], v[208:211]
  v_mfma_f32_16x16x32_bf16 v[212:215], v[252:255], v[124:127], v[212:215]
  ds_write_b128 v37, v[176:179] offset:36864
  ds_write_b128 v37, v[180:183] offset:37888
  ds_write_b128 v37, v[184:187] offset:38912
  ds_write_b128 v37, v[188:191] offset:39936
  ds_write_b128 v37, v[192:195] offset:40960
  v_mfma_f32_16x16x32_bf16 v[40:43], v[236:239], v[112:115], v[40:43]
  v_mfma_f32_16x16x32_bf16 v[44:47], v[240:243], v[112:115], v[44:47]
  v_mfma_f32_16x16x32_bf16 v[48:51], v[244:247], v[112:115], v[48:51]
  v_mfma_f32_16x16x32_bf16 v[52:55], v[248:251], v[112:115], v[52:55]
  v_mfma_f32_16x16x32_bf16 v[56:59], v[252:255], v[112:115], v[56:59]
  ds_write_b128 v37, v[196:199] offset:57344
  ds_write_b128 v37, v[200:203] offset:58368
  ds_write_b128 v37, v[204:207] offset:59392
  ds_write_b128 v37, v[208:211] offset:60416
  ds_write_b128 v37, v[212:215] offset:61440
  s_cmp_eq_u32 s77, 1
  s_cbranch_scc1 Lyok_15
  s_waitcnt vmcnt(0)
  v_not_b32 v32, s52
  v_cmp_ne_u32 vcc, s52, v32
  s_nop 0
  s_cmp_eq_u64 vcc, 0
  s_cbranch_scc1 Lok_17
  s_mov_b32 s60, 20000
Lspin_16:
  s_sleep 4
  buffer_load_dword v32, v4, s[12:15], s75 offen sc1
  s_waitcnt vmcnt(0)
  v_cmp_ne_u32 vcc, s52, v32
  s_nop 0
  s_cmp_eq_u64 vcc, 0
  s_cbranch_scc1 Lok_17
  s_sub_u32 s60, s60, 1
  s_cmp_lg_u32 s60, 0
  s_cbranch_scc1 Lspin_16
Lok_17:
  s_mov_b32 m0, s74
  s_nop 0
  buffer_load_dwordx4 v33, s[12:15], s76 offen sc1 lds
  buffer_load_dwordx4 v34, s[12:15], s76 offen offset:1024 sc1 lds
  s_mov_b64 exec, 0xffffffff
  buffer_load_dwordx4 v35, s[12:15], s76 offen offset:2048 sc1 lds
  s_mov_b64 exec, -1
Lyok_15:
  s_waitcnt vmcnt(0)
  ds_read_b64_tr_b16 v[156:157], v80 offset:0
  ds_read_b64_tr_b16 v[158:159], v80 offset:512
  ds_read_b64_tr_b16 v[160:161], v80 offset:1024
  ds_read_b64_tr_b16 v[162:163], v80 offset:1536
  ds_read_b64_tr_b16 v[164:165], v80 offset:2048
  v_lshlrev_b32 v216, 16, v22
  v_and_b32 v217, 0xffff0000, v22
  v_lshlrev_b32 v218, 16, v23
  v_and_b32 v219, 0xffff0000, v23
  v_lshlrev_b32 v224, 16, v24
  v_and_b32 v225, 0xffff0000, v24
  v_lshlrev_b32 v226, 16, v25
  v_and_b32 v227, 0xffff0000, v25
  v_lshlrev_b32 v232, 16, v26
  v_and_b32 v233, 0xffff0000, v26
  v_lshlrev_b32 v234, 16, v27
  v_and_b32 v235, 0xffff0000, v27
  v_lshlrev_b32 v240, 16, v28
  v_and_b32 v241, 0xffff0000, v28
  v_lshlrev_b32 v242, 16, v29
  v_and_b32 v243, 0xffff0000, v29
  v_lshlrev_b32 v248, 16, v30
  v_and_b32 v249, 0xffff0000, v30
  v_lshlrev_b32 v250, 16, v31
  v_and_b32 v251, 0xffff0000, v31
  s_waitcnt lgkmcnt(0)
  s_barrier
  ds_read_b128 v[96:99], v85 offset:16384
  ds_read_b128 v[100:103], v86 offset:36864
  ds_read_b128 v[104:107], v87 offset:57344
  ds_read_b128 v[108:111], v85 offset:17408
  ds_read_b128 v[112:115], v86 offset:37888
  ds_read_b128 v[116:119], v87 offset:58368
  ds_read_b128 v[120:123], v85 offset:18432
  ds_read_b128 v[124:127], v86 offset:38912
  ds_read_b128 v[128:131], v87 offset:59392
  ds_read_b128 v[132:135], v85 offset:19456
  ds_read_b128 v[136:139], v86 offset:39936
  ds_read_b128 v[140:143], v87 offset:60416
  ds_read_b128 v[144:147], v85 offset:20480
  ds_read_b128 v[148:151], v86 offset:40960
  ds_read_b128 v[152:155], v87 offset:61440
  v_lshlrev_b32 v220, 16, v156
  v_and_b32 v221, 0xffff0000, v156
  v_lshlrev_b32 v222, 16, v157
  v_and_b32 v223, 0xffff0000, v157
  v_pk_add_f32 v[216:217], v[216:217], v[220:221]
  v_pk_add_f32 v[218:219], v[218:219], v[222:223]
  v_cvt_pk_bf16_f32 v220, v216, v217
  v_cvt_pk_bf16_f32 v221, v218, v219
  v_lshlrev_b32 v216, 16, v220
  v_and_b32 v217, 0xffff0000, v220
  v_lshlrev_b32 v218, 16, v221
  v_and_b32 v219, 0xffff0000, v221
  v_lshlrev_b32 v228, 16, v158
  v_and_b32 v229, 0xffff0000, v158
  v_lshlrev_b32 v230, 16, v159
  v_and_b32 v231, 0xffff0000, v159
  v_pk_add_f32 v[224:225], v[224:225], v[228:229]
  v_pk_add_f32 v[226:227], v[226:227], v[230:231]
  v_cvt_pk_bf16_f32 v228, v224, v225
  v_cvt_pk_bf16_f32 v229, v226, v227
  v_lshlrev_b32 v224, 16, v228
  v_and_b32 v225, 0xffff0000, v228
  v_lshlrev_b32 v226, 16, v229
  v_and_b32 v227, 0xffff0000, v229
  v_lshlrev_b32 v236, 16, v160
  v_and_b32 v237, 0xffff0000, v160
  v_lshlrev_b32 v238, 16, v161
  v_and_b32 v239, 0xffff0000, v161
  v_pk_add_f32 v[232:233], v[232:233], v[236:237]
  v_pk_add_f32 v[234:235], v[234:235], v[238:239]
  v_cvt_pk_bf16_f32 v236, v232, v233
  v_cvt_pk_bf16_f32 v237, v234, v235
  v_lshlrev_b32 v232, 16, v236
  v_and_b32 v233, 0xffff0000, v236
  v_lshlrev_b32 v234, 16, v237
  v_and_b32 v235, 0xffff0000, v237
  v_lshlrev_b32 v244, 16, v162
  v_and_b32 v245, 0xffff0000, v162
  v_lshlrev_b32 v246, 16, v163
  v_and_b32 v247, 0xffff0000, v163
  v_pk_add_f32 v[240:241], v[240:241], v[244:245]
  v_pk_add_f32 v[242:243], v[242:243], v[246:247]
  v_cvt_pk_bf16_f32 v244, v240, v241
  v_cvt_pk_bf16_f32 v245, v242, v243
  v_lshlrev_b32 v240, 16, v244
  v_and_b32 v241, 0xffff0000, v244
  v_lshlrev_b32 v242, 16, v245
  v_and_b32 v243, 0xffff0000, v245
  v_lshlrev_b32 v252, 16, v164
  v_and_b32 v253, 0xffff0000, v164
  v_lshlrev_b32 v254, 16, v165
  v_and_b32 v255, 0xffff0000, v165
  v_pk_add_f32 v[248:249], v[248:249], v[252:253]
  v_pk_add_f32 v[250:251], v[250:251], v[254:255]
  v_cvt_pk_bf16_f32 v252, v248, v249
  v_cvt_pk_bf16_f32 v253, v250, v251
  v_lshlrev_b32 v248, 16, v252
  v_and_b32 v249, 0xffff0000, v252
  v_lshlrev_b32 v250, 16, v253
  v_and_b32 v251, 0xffff0000, v253
  s_waitcnt lgkmcnt(12)
  v_pk_add_f32 v[40:41], v[40:41], v[96:97]
  v_pk_add_f32 v[42:43], v[42:43], v[98:99]
  v_pk_add_f32 v[100:101], v[100:101], v[104:105]
  v_pk_add_f32 v[102:103], v[102:103], v[106:107]
  v_pk_add_f32 v[40:41], v[40:41], v[100:101]
  v_pk_add_f32 v[42:43], v[42:43], v[102:103]
  v_cvt_pk_bf16_f32 v96, v40, v41
  v_cvt_pk_bf16_f32 v97, v42, v43
  v_lshlrev_b32 v40, 16, v96
  v_and_b32 v41, 0xffff0000, v96
  v_lshlrev_b32 v42, 16, v97
  v_and_b32 v43, 0xffff0000, v97
  v_pk_add_f32 v[216:217], v[216:217], v[40:41]
  v_pk_add_f32 v[218:219], v[218:219], v[42:43]
  v_cvt_pk_bf16_f32 v220, v216, v217
  v_cvt_pk_bf16_f32 v221, v218, v219
  buffer_store_dwordx2 v[220:221], v3, s[48:51], 0 offen offset:0
  s_waitcnt lgkmcnt(9)
  v_pk_add_f32 v[44:45], v[44:45], v[108:109]
  v_pk_add_f32 v[46:47], v[46:47], v[110:111]
  v_pk_add_f32 v[112:113], v[112:113], v[116:117]
  v_pk_add_f32 v[114:115], v[114:115], v[118:119]
  v_pk_add_f32 v[44:45], v[44:45], v[112:113]
  v_pk_add_f32 v[46:47], v[46:47], v[114:115]
  v_cvt_pk_bf16_f32 v108, v44, v45
  v_cvt_pk_bf16_f32 v109, v46, v47
  v_lshlrev_b32 v44, 16, v108
  v_and_b32 v45, 0xffff0000, v108
  v_lshlrev_b32 v46, 16, v109
  v_and_b32 v47, 0xffff0000, v109
  v_pk_add_f32 v[224:225], v[224:225], v[44:45]
  v_pk_add_f32 v[226:227], v[226:227], v[46:47]
  v_cvt_pk_bf16_f32 v228, v224, v225
  v_cvt_pk_bf16_f32 v229, v226, v227
  buffer_store_dwordx2 v[228:229], v3, s[48:51], 0 offen offset:32
  s_waitcnt lgkmcnt(6)
  v_pk_add_f32 v[48:49], v[48:49], v[120:121]
  v_pk_add_f32 v[50:51], v[50:51], v[122:123]
  v_pk_add_f32 v[124:125], v[124:125], v[128:129]
  v_pk_add_f32 v[126:127], v[126:127], v[130:131]
  v_pk_add_f32 v[48:49], v[48:49], v[124:125]
  v_pk_add_f32 v[50:51], v[50:51], v[126:127]
  v_cvt_pk_bf16_f32 v120, v48, v49
  v_cvt_pk_bf16_f32 v121, v50, v51
  v_lshlrev_b32 v48, 16, v120
  v_and_b32 v49, 0xffff0000, v120
  v_lshlrev_b32 v50, 16, v121
  v_and_b32 v51, 0xffff0000, v121
  v_pk_add_f32 v[232:233], v[232:233], v[48:49]
  v_pk_add_f32 v[234:235], v[234:235], v[50:51]
  v_cvt_pk_bf16_f32 v236, v232, v233
  v_cvt_pk_bf16_f32 v237, v234, v235
  buffer_store_dwordx2 v[236:237], v3, s[48:51], 0 offen offset:64
  s_waitcnt lgkmcnt(3)
  v_pk_add_f32 v[52:53], v[52:53], v[132:133]
  v_pk_add_f32 v[54:55], v[54:55], v[134:135]
  v_pk_add_f32 v[136:137], v[136:137], v[140:141]
  v_pk_add_f32 v[138:139], v[138:139], v[142:143]
  v_pk_add_f32 v[52:53], v[52:53], v[136:137]
  v_pk_add_f32 v[54:55], v[54:55], v[138:139]
  v_cvt_pk_bf16_f32 v132, v52, v53
  v_cvt_pk_bf16_f32 v133, v54, v55
  v_lshlrev_b32 v52, 16, v132
  v_and_b32 v53, 0xffff0000, v132
  v_lshlrev_b32 v54, 16, v133
  v_and_b32 v55, 0xffff0000, v133
  v_pk_add_f32 v[240:241], v[240:241], v[52:53]
  v_pk_add_f32 v[242:243], v[242:243], v[54:55]
  v_cvt_pk_bf16_f32 v244, v240, v241
  v_cvt_pk_bf16_f32 v245, v242, v243
  buffer_store_dwordx2 v[244:245], v3, s[48:51], 0 offen offset:96
  s_waitcnt lgkmcnt(0)
  v_pk_add_f32 v[56:57], v[56:57], v[144:145]
  v_pk_add_f32 v[58:59], v[58:59], v[146:147]
  v_pk_add_f32 v[148:149], v[148:149], v[152:153]
  v_pk_add_f32 v[150:151], v[150:151], v[154:155]
  v_pk_add_f32 v[56:57], v[56:57], v[148:149]
  v_pk_add_f32 v[58:59], v[58:59], v[150:151]
  v_cvt_pk_bf16_f32 v144, v56, v57
  v_cvt_pk_bf16_f32 v145, v58, v59
  v_lshlrev_b32 v56, 16, v144
  v_and_b32 v57, 0xffff0000, v144
  v_lshlrev_b32 v58, 16, v145
  v_and_b32 v59, 0xffff0000, v145
  v_pk_add_f32 v[248:249], v[248:249], v[56:57]
  v_pk_add_f32 v[250:251], v[250:251], v[58:59]
  v_cvt_pk_bf16_f32 v252, v248, v249
  v_cvt_pk_bf16_f32 v253, v250, v251
  buffer_store_dwordx2 v[252:253], v3, s[48:51], 0 offen offset:128
  s_endpgm
Lssm:
  s_setprio 3
  s_mov_b32 s54, s2
  s_lshr_b32 s56, s54, 1
  s_mul_i32 s56, s56, 5
  s_and_b32 s57, s54, 1
  s_mul_i32 s58, s57, 3
  s_add_u32 s58, s58, s56
  s_add_u32 s59, s58, 1
  s_add_u32 s61, s56, 2
  s_lshl_b32 s70, s58, 1
  s_and_b32 s70, s70, -4
  s_load_dword s34, s[32:33], s70
  s_lshl_b32 s70, s59, 1
  s_and_b32 s70, s70, -4
  s_load_dword s35, s[32:33], s70
  s_lshl_b32 s70, s61, 1
  s_and_b32 s70, s70, -4
  s_load_dword s42, s[32:33], s70
  s_cmp_eq_u32 s3, 3
  s_cbranch_scc1 Laux
  s_cmp_eq_u32 s3, 0
  s_cselect_b32 s55, s58, s59
  s_cmp_eq_u32 s3, 2
  s_cselect_b32 s55, s61, s55
  s_mul_i32 s68, s3, 18560
  s_mul_i32 s70, s55, 384
  v_mul_u32_u24 v1, 6, v0
  v_and_b32 v1, -4, v1
  v_add_u32 v1, s70, v1
  global_load_dwordx2 v[30:31], v1, s[18:19]
  global_load_dwordx2 v[32:33], v1, s[20:21]
  global_load_dwordx2 v[34:35], v1, s[22:23]
  global_load_dwordx2 v[36:37], v1, s[24:25]
  global_load_dwordx2 v[38:39], v1, s[26:27]
  global_load_dwordx2 v[40:41], v1, s[28:29]
  s_lshl_b32 s70, s55, 1
  s_and_b32 s70, s70, -4
  s_load_dword s69, s[30:31], s70
  v_and_b32 v2, 1, v0
  v_lshlrev_b32 v2, 4, v2
  s_mov_b32 m0, s68
  v_and_b32 v6, 15, v0
  v_mul_u32_u24 v7, 288, v6
  v_lshrrev_b32 v4, 4, v0
  v_lshl_add_u32 v7, v4, 4, v7
  v_add_u32 v7, s68, v7
  s_mov_b32 s48, s40
  s_mov_b32 s49, s41
  s_mov_b32 s50, 1966080
  s_mov_b32 s51, 0x20000
  s_mul_i32 s78, s2, 960
  s_add_u32 s78, s78, 7340032
  v_lshlrev_b32 v190, 4, v0
  v_mov_b32 v188, 0
  s_mov_b32 s79, 0
  s_cmp_lg_u32 s3, 7
  s_cbranch_scc1 Lkg_now2
  v_mul_u32_u24 v188, 6554, v0
  v_lshrrev_b32 v188, 16, v188
  v_mul_u32_u24 v189, 10, v188
  v_sub_u32 v189, v0, v189
  v_mul_u32_u24 v188, 0x500, v188
  v_lshl_add_u32 v188, v189, 4, v188
  s_mul_i32 s71, s2, 7680
  s_mov_b32 exec_hi, 0x0fffffff
  s_mov_b32 s79, s71
  s_mov_b32 exec_hi, -1
Lkg_now2:
  s_setprio 1
  s_waitcnt lgkmcnt(0)
  s_mul_i32 s52, s53, 0x9E3779B1
  s_add_u32 s52, s52, 0x7F4A7C15
  s_bitcmp1_b32 s55, 0
  s_cselect_b32 s70, 0, 16
  s_lshl_b32 s69, s69, s70
  s_and_b32 s69, s69, 0xffff0000
  v_mov_b32 v3, s69
  v_mul_f32 v4, 1069066811, v3
  s_mov_b32 s70, 1069066811
  v_fma_f32 v5, v3, s70, -v4
  v_fmac_f32 v5, 0x32A57060, v3
  v_exp_f32 v4, v4
  v_mul_f32 v5, 0x3F317218, v5
  v_fmac_f32 v4, v4, v5
  v_cvt_pk_bf16_f32 v4, v4, v4
  v_and_b32 v3, 0xffff0000, v4
  v_mov_b32 v176, 0
  v_mov_b32 v177, 0
  v_mov_b32 v178, 0
  v_mov_b32 v179, 0
  v_mov_b32 v180, 0
  v_mov_b32 v181, 0
  v_mov_b32 v182, 0
  v_mov_b32 v183, 0
  v_mov_b32 v184, 0
  v_mov_b32 v185, 0
  v_mov_b32 v186, 0
  v_mov_b32 v187, 0
  s_waitcnt vmcnt(0)
  s_cmp_eq_u32 s3, 0
  s_cbranch_scc1 Lkw_18
  s_waitcnt vmcnt(0)
Lkw_18:
  v_alignbit_b32 v30, v31, v30, v2
  v_lshrrev_b32 v31, v2, v31
  v_lshlrev_b32 v8, 16, v30
  v_and_b32 v14, 0xffff0000, v30
  v_lshlrev_b32 v20, 16, v31
  v_alignbit_b32 v32, v33, v32, v2
  v_lshrrev_b32 v33, v2, v33
  v_lshlrev_b32 v9, 16, v32
  v_and_b32 v15, 0xffff0000, v32
  v_lshlrev_b32 v21, 16, v33
  v_alignbit_b32 v34, v35, v34, v2
  v_lshrrev_b32 v35, v2, v35
  v_lshlrev_b32 v10, 16, v34
  v_and_b32 v16, 0xffff0000, v34
  v_lshlrev_b32 v22, 16, v35
  v_alignbit_b32 v36, v37, v36, v2
  v_lshrrev_b32 v37, v2, v37
  v_lshlrev_b32 v11, 16, v36
  v_and_b32 v17, 0xffff0000, v36
  v_lshlrev_b32 v23, 16, v37
  v_alignbit_b32 v38, v39, v38, v2
  v_lshrrev_b32 v39, v2, v39
  v_lshlrev_b32 v12, 16, v38
  v_and_b32 v18, 0xffff0000, v38
  v_lshlrev_b32 v24, 16, v39
  v_alignbit_b32 v40, v41, v40, v2
  v_lshrrev_b32 v41, v2, v41
  v_lshlrev_b32 v13, 16, v40
  v_and_b32 v19, 0xffff0000, v40
  v_lshlrev_b32 v25, 16, v41
  s_mov_b32 s69, 3
Lkg:
  v_mul_f32 v104, v3, v8
  v_mul_f32 v105, v3, v9
  v_mul_f32 v10, v3, v10
  v_mul_f32 v11, v3, v11
  v_mul_f32 v104, 1069066811, v104
  v_mul_f32 v105, 0.15915494, v105
  v_exp_f32 v80, v104
  v_fract_f32 v81, v105
  v_mul_f32 v82, 1090519040, v104
  v_mul_f32 v83, 1090519040, v105
  v_exp_f32 v82, v82
  v_fract_f32 v83, v83
  v_mul_f32 v84, 1124073472, v104
  v_mul_f32 v85, 1124073472, v105
  v_exp_f32 v84, v84
  v_fract_f32 v85, v85
  v_cos_f32 v30, v81
  v_sin_f32 v31, v81
  v_cos_f32 v44, v83
  v_sin_f32 v45, v83
  v_cos_f32 v74, v85
  v_sin_f32 v75, v85
  v_pk_mul_f32 v[76:77], v[12:13], v[10:11] op_sel:[0,0] op_sel_hi:[0,1]
  v_pk_fma_f32 v[76:77], v[12:13], v[10:11], v[76:77] op_sel:[1,1,0] op_sel_hi:[1,0,1] neg_lo:[1,0,0]
  v_mul_f32 v30, v30, v80
  v_mul_f32 v31, v31, v80
  v_mul_f32 v44, v44, v82
  v_mul_f32 v45, v45, v82
  v_mul_f32 v74, v74, v84
  v_mul_f32 v75, v75, v84
  v_pk_mul_f32 v[8:9], v[14:15], 1.0 op_sel_hi:[1,0]
  v_pk_mul_f32 v[10:11], v[16:17], 1.0 op_sel_hi:[1,0]
  v_pk_mul_f32 v[12:13], v[18:19], 1.0 op_sel_hi:[1,0]
  v_pk_mul_f32 v[14:15], v[20:21], 1.0 op_sel_hi:[1,0]
  v_pk_mul_f32 v[16:17], v[22:23], 1.0 op_sel_hi:[1,0]
  v_pk_mul_f32 v[18:19], v[24:25], 1.0 op_sel_hi:[1,0]
  v_mov_b32 v103, 0x3f80
  ds_write_addtid_b32 v103 offset:11808
  v_pk_mul_f32 v[32:33], v[30:31], v[30:31] op_sel:[0,0] op_sel_hi:[0,1]
  v_pk_mul_f32 v[46:47], v[44:45], v[44:45] op_sel:[0,0] op_sel_hi:[0,1]
  v_pk_mul_f32 v[78:79], v[76:77], v[74:75] op_sel:[0,0] op_sel_hi:[0,1]
  v_pk_fma_f32 v[32:33], v[30:31], v[30:31], v[32:33] op_sel:[1,1,0] op_sel_hi:[1,0,1] neg_lo:[1,0,0]
  v_pk_fma_f32 v[46:47], v[44:45], v[44:45], v[46:47] op_sel:[1,1,0] op_sel_hi:[1,0,1] neg_lo:[1,0,0]
  v_pk_fma_f32 v[78:79], v[76:77], v[74:75], v[78:79] op_sel:[1,1,0] op_sel_hi:[1,0,1] neg_lo:[1,0,0]
  v_cvt_pk_bf16_f32 v96, v76, v77
  v_cvt_pk_bf16_f32 v97, v78, v79
  ds_write_addtid_b32 v96 offset:0
  ds_write_addtid_b32 v97 offset:2304
  v_cvt_pk_bf16_f32 v98, v44, -v45
  v_cvt_pk_bf16_f32 v99, v46, -v47
  ds_write_addtid_b32 v98 offset:12096
  ds_write_addtid_b32 v99 offset:12384
  v_pk_mul_f32 v[34:35], v[32:33], v[30:31] op_sel:[0,0] op_sel_hi:[0,1]
  v_pk_mul_f32 v[36:37], v[32:33], v[32:33] op_sel:[0,0] op_sel_hi:[0,1]
  v_pk_mul_f32 v[48:49], v[46:47], v[44:45] op_sel:[0,0] op_sel_hi:[0,1]
  v_pk_mul_f32 v[50:51], v[46:47], v[46:47] op_sel:[0,0] op_sel_hi:[0,1]
  v_pk_mul_f32 v[80:81], v[76:77], v[30:31] op_sel:[0,0] op_sel_hi:[0,1]
  v_pk_mul_f32 v[82:83], v[76:77], v[32:33] op_sel:[0,0] op_sel_hi:[0,1]
  v_pk_mul_f32 v[84:85], v[78:79], v[30:31] op_sel:[0,0] op_sel_hi:[0,1]
  v_pk_mul_f32 v[86:87], v[78:79], v[32:33] op_sel:[0,0] op_sel_hi:[0,1]
  v_pk_fma_f32 v[34:35], v[32:33], v[30:31], v[34:35] op_sel:[1,1,0] op_sel_hi:[1,0,1] neg_lo:[1,0,0]
  v_pk_fma_f32 v[36:37], v[32:33], v[32:33], v[36:37] op_sel:[1,1,0] op_sel_hi:[1,0,1] neg_lo:[1,0,0]
  v_pk_fma_f32 v[48:49], v[46:47], v[44:45], v[48:49] op_sel:[1,1,0] op_sel_hi:[1,0,1] neg_lo:[1,0,0]
  v_pk_fma_f32 v[50:51], v[46:47], v[46:47], v[50:51] op_sel:[1,1,0] op_sel_hi:[1,0,1] neg_lo:[1,0,0]
  v_pk_fma_f32 v[80:81], v[76:77], v[30:31], v[80:81] op_sel:[1,1,0] op_sel_hi:[1,0,1] neg_lo:[1,0,0]
  v_pk_fma_f32 v[82:83], v[76:77], v[32:33], v[82:83] op_sel:[1,1,0] op_sel_hi:[1,0,1] neg_lo:[1,0,0]
  v_pk_fma_f32 v[84:85], v[78:79], v[30:31], v[84:85] op_sel:[1,1,0] op_sel_hi:[1,0,1] neg_lo:[1,0,0]
  v_pk_fma_f32 v[86:87], v[78:79], v[32:33], v[86:87] op_sel:[1,1,0] op_sel_hi:[1,0,1] neg_lo:[1,0,0]
  v_cvt_pk_bf16_f32 v100, v80, v81
  v_cvt_pk_bf16_f32 v101, v82, v83
  v_cvt_pk_bf16_f32 v102, v84, v85
  v_cvt_pk_bf16_f32 v103, v86, v87
  ds_write_addtid_b32 v100 offset:288
  ds_write_addtid_b32 v101 offset:576
  ds_write_addtid_b32 v102 offset:2592
  ds_write_addtid_b32 v103 offset:2880
  v_cvt_pk_bf16_f32 v96, v48, -v49
  v_cvt_pk_bf16_f32 v97, v50, -v51
  ds_write_addtid_b32 v96 offset:12672
  ds_write_addtid_b32 v97 offset:12960
  v_pk_mul_f32 v[38:39], v[36:37], v[30:31] op_sel:[0,0] op_sel_hi:[0,1]
  v_pk_mul_f32 v[40:41], v[36:37], v[32:33] op_sel:[0,0] op_sel_hi:[0,1]
  v_pk_mul_f32 v[42:43], v[36:37], v[34:35] op_sel:[0,0] op_sel_hi:[0,1]
  v_pk_mul_f32 v[52:53], v[50:51], v[44:45] op_sel:[0,0] op_sel_hi:[0,1]
  v_pk_mul_f32 v[54:55], v[50:51], v[46:47] op_sel:[0,0] op_sel_hi:[0,1]
  v_pk_mul_f32 v[56:57], v[50:51], v[48:49] op_sel:[0,0] op_sel_hi:[0,1]
  v_pk_mul_f32 v[58:59], v[50:51], v[50:51] op_sel:[0,0] op_sel_hi:[0,1]
  v_pk_mul_f32 v[80:81], v[76:77], v[34:35] op_sel:[0,0] op_sel_hi:[0,1]
  v_pk_mul_f32 v[82:83], v[76:77], v[36:37] op_sel:[0,0] op_sel_hi:[0,1]
  v_pk_mul_f32 v[84:85], v[78:79], v[34:35] op_sel:[0,0] op_sel_hi:[0,1]
  v_pk_mul_f32 v[86:87], v[78:79], v[36:37] op_sel:[0,0] op_sel_hi:[0,1]
  v_pk_fma_f32 v[38:39], v[36:37], v[30:31], v[38:39] op_sel:[1,1,0] op_sel_hi:[1,0,1] neg_lo:[1,0,0]
  v_pk_fma_f32 v[40:41], v[36:37], v[32:33], v[40:41] op_sel:[1,1,0] op_sel_hi:[1,0,1] neg_lo:[1,0,0]
  v_pk_fma_f32 v[42:43], v[36:37], v[34:35], v[42:43] op_sel:[1,1,0] op_sel_hi:[1,0,1] neg_lo:[1,0,0]
  v_pk_fma_f32 v[52:53], v[50:51], v[44:45], v[52:53] op_sel:[1,1,0] op_sel_hi:[1,0,1] neg_lo:[1,0,0]
  v_pk_fma_f32 v[54:55], v[50:51], v[46:47], v[54:55] op_sel:[1,1,0] op_sel_hi:[1,0,1] neg_lo:[1,0,0]
  v_pk_fma_f32 v[56:57], v[50:51], v[48:49], v[56:57] op_sel:[1,1,0] op_sel_hi:[1,0,1] neg_lo:[1,0,0]
  v_pk_fma_f32 v[58:59], v[50:51], v[50:51], v[58:59] op_sel:[1,1,0] op_sel_hi:[1,0,1] neg_lo:[1,0,0]
  v_pk_fma_f32 v[80:81], v[76:77], v[34:35], v[80:81] op_sel:[1,1,0] op_sel_hi:[1,0,1] neg_lo:[1,0,0]
  v_pk_fma_f32 v[82:83], v[76:77], v[36:37], v[82:83] op_sel:[1,1,0] op_sel_hi:[1,0,1] neg_lo:[1,0,0]
  v_pk_fma_f32 v[84:85], v[78:79], v[34:35], v[84:85] op_sel:[1,1,0] op_sel_hi:[1,0,1] neg_lo:[1,0,0]
  v_pk_fma_f32 v[86:87], v[78:79], v[36:37], v[86:87] op_sel:[1,1,0] op_sel_hi:[1,0,1] neg_lo:[1,0,0]
  v_cvt_pk_bf16_f32 v98, v80, v81
  v_cvt_pk_bf16_f32 v99, v82, v83
  v_cvt_pk_bf16_f32 v100, v84, v85
  v_cvt_pk_bf16_f32 v101, v86, v87
  ds_write_addtid_b32 v98 offset:864
  ds_write_addtid_b32 v99 offset:1152
  ds_write_addtid_b32 v100 offset:3168
  ds_write_addtid_b32 v101 offset:3456
  v_cvt_pk_bf16_f32 v102, v52, -v53
  v_cvt_pk_bf16_f32 v103, v54, -v55
  v_cvt_pk_bf16_f32 v96, v56, -v57
  v_cvt_pk_bf16_f32 v97, v58, -v59
  ds_write_addtid_b32 v102 offset:13248
  ds_write_addtid_b32 v103 offset:13536
  ds_write_addtid_b32 v96 offset:13824
  ds_write_addtid_b32 v97 offset:14112
  v_pk_mul_f32 v[80:81], v[76:77], v[38:39] op_sel:[0,0] op_sel_hi:[0,1]
  v_pk_mul_f32 v[82:83], v[76:77], v[40:41] op_sel:[0,0] op_sel_hi:[0,1]
  v_pk_mul_f32 v[84:85], v[76:77], v[42:43] op_sel:[0,0] op_sel_hi:[0,1]
  v_pk_mul_f32 v[86:87], v[78:79], v[38:39] op_sel:[0,0] op_sel_hi:[0,1]
  v_pk_mul_f32 v[88:89], v[78:79], v[40:41] op_sel:[0,0] op_sel_hi:[0,1]
  v_pk_mul_f32 v[90:91], v[78:79], v[42:43] op_sel:[0,0] op_sel_hi:[0,1]
  v_pk_mul_f32 v[60:61], v[58:59], v[44:45] op_sel:[0,0] op_sel_hi:[0,1]
  v_pk_mul_f32 v[62:63], v[58:59], v[46:47] op_sel:[0,0] op_sel_hi:[0,1]
  v_pk_mul_f32 v[64:65], v[58:59], v[48:49] op_sel:[0,0] op_sel_hi:[0,1]
  v_pk_mul_f32 v[66:67], v[58:59], v[50:51] op_sel:[0,0] op_sel_hi:[0,1]
  v_pk_mul_f32 v[68:69], v[58:59], v[52:53] op_sel:[0,0] op_sel_hi:[0,1]
  v_pk_mul_f32 v[70:71], v[58:59], v[54:55] op_sel:[0,0] op_sel_hi:[0,1]
  v_pk_mul_f32 v[72:73], v[58:59], v[56:57] op_sel:[0,0] op_sel_hi:[0,1]
  v_pk_mul_f32 v[92:93], v[74:75], v[74:75] op_sel:[0,0] op_sel_hi:[0,1]
  v_pk_mul_f32 v[94:95], v[78:79], v[74:75] op_sel:[0,0] op_sel_hi:[0,1]
  v_pk_fma_f32 v[80:81], v[76:77], v[38:39], v[80:81] op_sel:[1,1,0] op_sel_hi:[1,0,1] neg_lo:[1,0,0]
  v_pk_fma_f32 v[82:83], v[76:77], v[40:41], v[82:83] op_sel:[1,1,0] op_sel_hi:[1,0,1] neg_lo:[1,0,0]
  v_pk_fma_f32 v[84:85], v[76:77], v[42:43], v[84:85] op_sel:[1,1,0] op_sel_hi:[1,0,1] neg_lo:[1,0,0]
  v_pk_fma_f32 v[86:87], v[78:79], v[38:39], v[86:87] op_sel:[1,1,0] op_sel_hi:[1,0,1] neg_lo:[1,0,0]
  v_pk_fma_f32 v[88:89], v[78:79], v[40:41], v[88:89] op_sel:[1,1,0] op_sel_hi:[1,0,1] neg_lo:[1,0,0]
  v_pk_fma_f32 v[90:91], v[78:79], v[42:43], v[90:91] op_sel:[1,1,0] op_sel_hi:[1,0,1] neg_lo:[1,0,0]
  v_pk_fma_f32 v[60:61], v[58:59], v[44:45], v[60:61] op_sel:[1,1,0] op_sel_hi:[1,0,1] neg_lo:[1,0,0]
  v_pk_fma_f32 v[62:63], v[58:59], v[46:47], v[62:63] op_sel:[1,1,0] op_sel_hi:[1,0,1] neg_lo:[1,0,0]
  v_pk_fma_f32 v[64:65], v[58:59], v[48:49], v[64:65] op_sel:[1,1,0] op_sel_hi:[1,0,1] neg_lo:[1,0,0]
  v_pk_fma_f32 v[66:67], v[58:59], v[50:51], v[66:67] op_sel:[1,1,0] op_sel_hi:[1,0,1] neg_lo:[1,0,0]
  v_pk_fma_f32 v[68:69], v[58:59], v[52:53], v[68:69] op_sel:[1,1,0] op_sel_hi:[1,0,1] neg_lo:[1,0,0]
  v_pk_fma_f32 v[70:71], v[58:59], v[54:55], v[70:71] op_sel:[1,1,0] op_sel_hi:[1,0,1] neg_lo:[1,0,0]
  v_pk_fma_f32 v[72:73], v[58:59], v[56:57], v[72:73] op_sel:[1,1,0] op_sel_hi:[1,0,1] neg_lo:[1,0,0]
  v_pk_fma_f32 v[92:93], v[74:75], v[74:75], v[92:93] op_sel:[1,1,0] op_sel_hi:[1,0,1] neg_lo:[1,0,0]
  v_pk_fma_f32 v[94:95], v[78:79], v[74:75], v[94:95] op_sel:[1,1,0] op_sel_hi:[1,0,1] neg_lo:[1,0,0]
  v_cvt_pk_bf16_f32 v98, v80, v81
  v_cvt_pk_bf16_f32 v99, v82, v83
  v_cvt_pk_bf16_f32 v100, v84, v85
  v_cvt_pk_bf16_f32 v101, v86, v87
  v_cvt_pk_bf16_f32 v102, v88, v89
  v_cvt_pk_bf16_f32 v103, v90, v91
  ds_write_addtid_b32 v98 offset:1440
  ds_write_addtid_b32 v99 offset:1728
  ds_write_addtid_b32 v100 offset:2016
  ds_write_addtid_b32 v101 offset:3744
  ds_write_addtid_b32 v102 offset:4032
  ds_write_addtid_b32 v103 offset:4320
  v_pk_mul_f32 v[76:77], v[78:79], v[92:93] op_sel:[0,0] op_sel_hi:[0,1]
  v_pk_mul_f32 v[80:81], v[94:95], v[32:33] op_sel:[0,0] op_sel_hi:[0,1]
  v_pk_mul_f32 v[82:83], v[94:95], v[36:37] op_sel:[0,0] op_sel_hi:[0,1]
  v_pk_mul_f32 v[84:85], v[94:95], v[40:41] op_sel:[0,0] op_sel_hi:[0,1]
  v_pk_fma_f32 v[76:77], v[78:79], v[92:93], v[76:77] op_sel:[1,1,0] op_sel_hi:[1,0,1] neg_lo:[1,0,0]
  v_pk_fma_f32 v[80:81], v[94:95], v[32:33], v[80:81] op_sel:[1,1,0] op_sel_hi:[1,0,1] neg_lo:[1,0,0]
  v_pk_fma_f32 v[82:83], v[94:95], v[36:37], v[82:83] op_sel:[1,1,0] op_sel_hi:[1,0,1] neg_lo:[1,0,0]
  v_pk_fma_f32 v[84:85], v[94:95], v[40:41], v[84:85] op_sel:[1,1,0] op_sel_hi:[1,0,1] neg_lo:[1,0,0]
  v_pk_mul_f32 v[78:79], v[94:95], v[92:93] op_sel:[0,0] op_sel_hi:[0,1]
  v_pk_fma_f32 v[78:79], v[94:95], v[92:93], v[78:79] op_sel:[1,1,0] op_sel_hi:[1,0,1] neg_lo:[1,0,0]
  v_cvt_pk_bf16_f32 v96, v60, -v61
  v_cvt_pk_bf16_f32 v97, v62, -v63
  v_cvt_pk_bf16_f32 v98, v64, -v65
  v_cvt_pk_bf16_f32 v99, v66, -v67
  v_cvt_pk_bf16_f32 v100, v68, -v69
  v_cvt_pk_bf16_f32 v101, v70, -v71
  v_cvt_pk_bf16_f32 v102, v72, -v73
  ds_write_addtid_b32 v96 offset:14400
  ds_write_addtid_b32 v97 offset:14688
  ds_write_addtid_b32 v98 offset:14976
  ds_write_addtid_b32 v99 offset:15264
  ds_write_addtid_b32 v100 offset:15552
  ds_write_addtid_b32 v101 offset:15840
  ds_write_addtid_b32 v102 offset:16128
  v_cvt_pk_bf16_f32 v103, v94, v95
  v_cvt_pk_bf16_f32 v96, v80, v81
  v_cvt_pk_bf16_f32 v97, v82, v83
  v_cvt_pk_bf16_f32 v98, v84, v85
  ds_write_addtid_b32 v103 offset:4608
  ds_write_addtid_b32 v96 offset:4896
  ds_write_addtid_b32 v97 offset:5184
  ds_write_addtid_b32 v98 offset:5472
  v_pk_mul_f32 v[60:61], v[76:77], v[92:93] op_sel:[0,0] op_sel_hi:[0,1]
  v_pk_mul_f32 v[62:63], v[78:79], v[92:93] op_sel:[0,0] op_sel_hi:[0,1]
  v_pk_mul_f32 v[80:81], v[76:77], v[32:33] op_sel:[0,0] op_sel_hi:[0,1]
  v_pk_mul_f32 v[82:83], v[76:77], v[36:37] op_sel:[0,0] op_sel_hi:[0,1]
  v_pk_mul_f32 v[84:85], v[76:77], v[40:41] op_sel:[0,0] op_sel_hi:[0,1]
  v_pk_mul_f32 v[86:87], v[78:79], v[36:37] op_sel:[0,0] op_sel_hi:[0,1]
  v_pk_fma_f32 v[60:61], v[76:77], v[92:93], v[60:61] op_sel:[1,1,0] op_sel_hi:[1,0,1] neg_lo:[1,0,0]
  v_pk_fma_f32 v[62:63], v[78:79], v[92:93], v[62:63] op_sel:[1,1,0] op_sel_hi:[1,0,1] neg_lo:[1,0,0]
  v_pk_fma_f32 v[80:81], v[76:77], v[32:33], v[80:81] op_sel:[1,1,0] op_sel_hi:[1,0,1] neg_lo:[1,0,0]
  v_pk_fma_f32 v[82:83], v[76:77], v[36:37], v[82:83] op_sel:[1,1,0] op_sel_hi:[1,0,1] neg_lo:[1,0,0]
  v_pk_fma_f32 v[84:85], v[76:77], v[40:41], v[84:85] op_sel:[1,1,0] op_sel_hi:[1,0,1] neg_lo:[1,0,0]
  v_pk_fma_f32 v[86:87], v[78:79], v[36:37], v[86:87] op_sel:[1,1,0] op_sel_hi:[1,0,1] neg_lo:[1,0,0]
  v_cvt_pk_bf16_f32 v99, v76, v77
  v_cvt_pk_bf16_f32 v100, v80, v81
  v_cvt_pk_bf16_f32 v101, v82, v83
  v_cvt_pk_bf16_f32 v102, v84, v85
  v_cvt_pk_bf16_f32 v103, v78, v79
  v_cvt_pk_bf16_f32 v96, v86, v87
  ds_write_addtid_b32 v99 offset:5760
  ds_write_addtid_b32 v100 offset:6048
  ds_write_addtid_b32 v101 offset:6336
  ds_write_addtid_b32 v102 offset:6624
  ds_write_addtid_b32 v103 offset:6912
  ds_write_addtid_b32 v96 offset:7200
  v_pk_mul_f32 v[76:77], v[60:61], v[92:93] op_sel:[0,0] op_sel_hi:[0,1]
  v_pk_mul_f32 v[78:79], v[62:63], v[92:93] op_sel:[0,0] op_sel_hi:[0,1]
  v_pk_mul_f32 v[80:81], v[60:61], v[36:37] op_sel:[0,0] op_sel_hi:[0,1]
  v_pk_mul_f32 v[82:83], v[62:63], v[36:37] op_sel:[0,0] op_sel_hi:[0,1]
  v_pk_fma_f32 v[76:77], v[60:61], v[92:93], v[76:77] op_sel:[1,1,0] op_sel_hi:[1,0,1] neg_lo:[1,0,0]
  v_pk_fma_f32 v[78:79], v[62:63], v[92:93], v[78:79] op_sel:[1,1,0] op_sel_hi:[1,0,1] neg_lo:[1,0,0]
  v_pk_fma_f32 v[80:81], v[60:61], v[36:37], v[80:81] op_sel:[1,1,0] op_sel_hi:[1,0,1] neg_lo:[1,0,0]
  v_pk_fma_f32 v[82:83], v[62:63], v[36:37], v[82:83] op_sel:[1,1,0] op_sel_hi:[1,0,1] neg_lo:[1,0,0]
  v_cvt_pk_bf16_f32 v97, v60, v61
  v_cvt_pk_bf16_f32 v98, v80, v81
  v_cvt_pk_bf16_f32 v99, v62, v63
  v_cvt_pk_bf16_f32 v100, v82, v83
  ds_write_addtid_b32 v97 offset:7488
  ds_write_addtid_b32 v98 offset:7776
  ds_write_addtid_b32 v99 offset:8064
  ds_write_addtid_b32 v100 offset:8352
  v_pk_mul_f32 v[60:61], v[76:77], v[92:93] op_sel:[0,0] op_sel_hi:[0,1]
  v_pk_mul_f32 v[62:63], v[78:79], v[92:93] op_sel:[0,0] op_sel_hi:[0,1]
  v_pk_mul_f32 v[80:81], v[76:77], v[36:37] op_sel:[0,0] op_sel_hi:[0,1]
  v_pk_mul_f32 v[64:65], v[92:93], v[92:93] op_sel:[0,0] op_sel_hi:[0,1]
  v_pk_fma_f32 v[60:61], v[76:77], v[92:93], v[60:61] op_sel:[1,1,0] op_sel_hi:[1,0,1] neg_lo:[1,0,0]
  v_pk_fma_f32 v[62:63], v[78:79], v[92:93], v[62:63] op_sel:[1,1,0] op_sel_hi:[1,0,1] neg_lo:[1,0,0]
  v_pk_fma_f32 v[80:81], v[76:77], v[36:37], v[80:81] op_sel:[1,1,0] op_sel_hi:[1,0,1] neg_lo:[1,0,0]
  v_pk_fma_f32 v[64:65], v[92:93], v[92:93], v[64:65] op_sel:[1,1,0] op_sel_hi:[1,0,1] neg_lo:[1,0,0]
  v_cvt_pk_bf16_f32 v101, v76, v77
  v_cvt_pk_bf16_f32 v102, v80, v81
  v_cvt_pk_bf16_f32 v103, v78, v79
  ds_write_addtid_b32 v101 offset:8640
  ds_write_addtid_b32 v102 offset:8928
  ds_write_addtid_b32 v103 offset:9216
  v_pk_mul_f32 v[76:77], v[60:61], v[92:93] op_sel:[0,0] op_sel_hi:[0,1]
  v_pk_mul_f32 v[80:81], v[78:79], v[64:65] op_sel:[0,0] op_sel_hi:[0,1]
  v_pk_mul_f32 v[82:83], v[60:61], v[64:65] op_sel:[0,0] op_sel_hi:[0,1]
  v_pk_mul_f32 v[84:85], v[62:63], v[64:65] op_sel:[0,0] op_sel_hi:[0,1]
  v_pk_fma_f32 v[76:77], v[60:61], v[92:93], v[76:77] op_sel:[1,1,0] op_sel_hi:[1,0,1] neg_lo:[1,0,0]
  v_pk_fma_f32 v[80:81], v[78:79], v[64:65], v[80:81] op_sel:[1,1,0] op_sel_hi:[1,0,1] neg_lo:[1,0,0]
  v_pk_fma_f32 v[82:83], v[60:61], v[64:65], v[82:83] op_sel:[1,1,0] op_sel_hi:[1,0,1] neg_lo:[1,0,0]
  v_pk_fma_f32 v[84:85], v[62:63], v[64:65], v[84:85] op_sel:[1,1,0] op_sel_hi:[1,0,1] neg_lo:[1,0,0]
  v_cvt_pk_bf16_f32 v96, v60, v61
  v_cvt_pk_bf16_f32 v97, v62, v63
  ds_write_addtid_b32 v96 offset:9504
  ds_write_addtid_b32 v97 offset:9792
  v_pk_mul_f32 v[86:87], v[76:77], v[64:65] op_sel:[0,0] op_sel_hi:[0,1]
  v_pk_mul_f32 v[88:89], v[80:81], v[64:65] op_sel:[0,0] op_sel_hi:[0,1]
  v_pk_fma_f32 v[86:87], v[76:77], v[64:65], v[86:87] op_sel:[1,1,0] op_sel_hi:[1,0,1] neg_lo:[1,0,0]
  v_pk_fma_f32 v[88:89], v[80:81], v[64:65], v[88:89] op_sel:[1,1,0] op_sel_hi:[1,0,1] neg_lo:[1,0,0]
  v_cvt_pk_bf16_f32 v98, v76, v77
  v_cvt_pk_bf16_f32 v99, v80, v81
  v_cvt_pk_bf16_f32 v100, v82, v83
  v_cvt_pk_bf16_f32 v101, v84, v85
  ds_write_addtid_b32 v98 offset:10080
  ds_write_addtid_b32 v99 offset:10368
  ds_write_addtid_b32 v100 offset:10656
  ds_write_addtid_b32 v101 offset:10944
  v_cvt_pk_bf16_f32 v102, v86, v87
  v_cvt_pk_bf16_f32 v103, v88, v89
  ds_write_addtid_b32 v102 offset:11232
  ds_write_addtid_b32 v103 offset:11520
  s_waitcnt lgkmcnt(0)
  ds_read_b128 v[124:127], v7 offset:11808
  ds_read_b128 v[112:115], v7 offset:0
  ds_read_b128 v[116:119], v7 offset:4608
  ds_read_b128 v[120:123], v7 offset:9216
  ds_read_b128 v[140:143], v7 offset:11872
  ds_read_b128 v[128:131], v7 offset:64
  ds_read_b128 v[132:135], v7 offset:4672
  ds_read_b128 v[136:139], v7 offset:9280
  ds_read_b128 v[156:159], v7 offset:11936
  ds_read_b128 v[144:147], v7 offset:128
  ds_read_b128 v[148:151], v7 offset:4736
  ds_read_b128 v[152:155], v7 offset:9344
  ds_read_b128 v[172:175], v7 offset:12000
  ds_read_b128 v[160:163], v7 offset:192
  ds_read_b128 v[164:167], v7 offset:4800
  ds_read_b128 v[168:171], v7 offset:9408
  s_waitcnt lgkmcnt(12)
  v_mfma_f32_16x16x32_bf16 v[176:179], v[112:115], v[124:127], v[176:179]
  v_mfma_f32_16x16x32_bf16 v[180:183], v[116:119], v[124:127], v[180:183]
  v_mfma_f32_16x16x32_bf16 v[184:187], v[120:123], v[124:127], v[184:187]
  s_waitcnt lgkmcnt(8)
  v_mfma_f32_16x16x32_bf16 v[176:179], v[128:131], v[140:143], v[176:179]
  v_mfma_f32_16x16x32_bf16 v[180:183], v[132:135], v[140:143], v[180:183]
  v_mfma_f32_16x16x32_bf16 v[184:187], v[136:139], v[140:143], v[184:187]
  s_waitcnt lgkmcnt(4)
  v_mfma_f32_16x16x32_bf16 v[176:179], v[144:147], v[156:159], v[176:179]
  v_mfma_f32_16x16x32_bf16 v[180:183], v[148:151], v[156:159], v[180:183]
  v_mfma_f32_16x16x32_bf16 v[184:187], v[152:155], v[156:159], v[184:187]
  s_waitcnt lgkmcnt(0)
  v_mfma_f32_16x16x32_bf16 v[176:179], v[160:163], v[172:175], v[176:179]
  v_mfma_f32_16x16x32_bf16 v[180:183], v[164:167], v[172:175], v[180:183]
  v_mfma_f32_16x16x32_bf16 v[184:187], v[168:171], v[172:175], v[184:187]
  s_sub_u32 s69, s69, 1
  s_cmp_lg_u32 s3, 7
  s_cbranch_scc1 Lkg_n
  s_cmp_eq_u32 s69, 1
  s_cbranch_scc0 Lkg_f
  s_waitcnt vmcnt(0)
  s_mov_b32 exec_hi, 0x0fffffff
  buffer_store_dwordx4 v[192:195], v190, s[12:15], s78 offen sc1
  s_add_u32 s78, s78, 245760
  buffer_store_dwordx4 v[196:199], v190, s[12:15], s78 offen sc1
  s_add_u32 s78, s78, 245760
  buffer_store_dwordx4 v[200:203], v190, s[12:15], s78 offen sc1
  s_add_u32 s78, s78, 245760
  buffer_store_dwordx4 v[204:207], v190, s[12:15], s78 offen sc1
  s_add_u32 s78, s78, 245760
  buffer_store_dwordx4 v[208:211], v190, s[12:15], s78 offen sc1
  s_add_u32 s78, s78, 245760
  buffer_store_dwordx4 v[212:215], v190, s[12:15], s78 offen sc1
  s_add_u32 s78, s78, 245760
  buffer_store_dwordx4 v[216:219], v190, s[12:15], s78 offen sc1
  s_add_u32 s78, s78, 245760
  buffer_store_dwordx4 v[220:223], v190, s[12:15], s78 offen sc1
  s_mov_b32 exec_hi, -1
  s_branch Lkg
Lkg_f:
  s_cmp_eq_u32 s69, 2
  s_cbranch_scc0 Lkg_g
  s_mov_b32 exec_hi, 0x0fffffff
  buffer_load_dwordx4 v[192:195], v188, s[48:51], s79 offen offset:0
  buffer_load_dwordx4 v[196:199], v188, s[48:51], s79 offen offset:160
  buffer_load_dwordx4 v[200:203], v188, s[48:51], s79 offen offset:320
  buffer_load_dwordx4 v[204:207], v188, s[48:51], s79 offen offset:480
  buffer_load_dwordx4 v[208:211], v188, s[48:51], s79 offen offset:640
  buffer_load_dwordx4 v[212:215], v188, s[48:51], s79 offen offset:800
  buffer_load_dwordx4 v[216:219], v188, s[48:51], s79 offen offset:960
  buffer_load_dwordx4 v[220:223], v188, s[48:51], s79 offen offset:1120
  s_mov_b32 exec_hi, -1
  s_branch Lkg
Lkg_g:
  s_cmp_eq_u32 s69, 0
  s_cbranch_scc0 Lkg_n
  s_lshl_b32 s70, s2, 7
  s_add_u32 s70, s70, 425984
  s_waitcnt vmcnt(0)
  v_mov_b32 v190, s52
  v_mov_b32 v191, 0
  s_mov_b64 exec, 1
  buffer_store_dword v190, v191, s[12:15], s70 offen sc1
  s_mov_b64 exec, -1
Lkg_n:
  s_cmp_lg_u32 s69, 0
  s_cbranch_scc1 Lkg
  v_mov_b32 v21, 0
  s_and_b32 s75, s2, 7
  s_lshl_b32 s75, s75, 7
  s_add_u32 s75, s75, 4096
  buffer_load_dword v20, v21, s[12:15], s75 offen sc1
  s_waitcnt vmcnt(0)
  v_cmp_ne_u32 vcc, s52, v20
  s_nop 0
  s_cmp_eq_u64 vcc, 0
  s_cbranch_scc1 Lok_20
  s_mov_b32 s60, 20000
Lspin_19:
  s_sleep 3
  buffer_load_dword v20, v21, s[12:15], s75 offen sc1
  s_waitcnt vmcnt(0)
  v_cmp_ne_u32 vcc, s52, v20
  s_nop 0
  s_cmp_eq_u64 vcc, 0
  s_cbranch_scc1 Lok_20
  s_sub_u32 s60, s60, 1
  s_cmp_lg_u32 s60, 0
  s_cbranch_scc1 Lspin_19
Lok_20:
  v_lshlrev_b32 v224, 4, v0
  s_lshl_b32 s70, s3, 10
  v_add_u32 v224, s70, v224
  v_lshlrev_b32 v225, 1, v224
  s_mov_b32 s70, 196608
  buffer_load_dwordx4 v[200:203], v225, s[12:15], s70 offen sc1
  buffer_load_dwordx4 v[204:207], v225, s[12:15], s70 offen offset:16 sc1
  s_lshl_b32 s70, s58, 12
  s_add_u32 s70, s70, 1048576
  buffer_load_dwordx4 v[208:211], v224, s[12:15], s70 offen sc1
  s_lshl_b32 s70, s59, 12
  s_add_u32 s70, s70, 1048576
  buffer_load_dwordx4 v[212:215], v224, s[12:15], s70 offen sc1
  s_lshl_b32 s70, s61, 12
  s_add_u32 s70, s70, 1048576
  buffer_load_dwordx4 v[216:219], v224, s[12:15], s70 offen sc1
  v_lshrrev_b32 v4, 4, v0
  v_lshrrev_b32 v8, 1, v4
  v_and_b32 v9, 1, v4
  v_lshlrev_b32 v10, 8, v8
  v_lshl_add_u32 v10, v6, 4, v10
  v_lshl_add_u32 v10, v9, 3, v10
  v_add_u32 v10, s68, v10
  v_lshlrev_b32 v11, 7, v4
  v_add_u32 v11, 512, v11
  v_sub_u32 v12, 3, v8
  v_lshlrev_b32 v12, v12, v6
  v_add_u32 v11, v11, v12
  v_add_u32 v11, s68, v11
  v_mul_u32_u24 v12, 60, v8
  v_add_u32 v12, 4, v12
  v_add_u32 v12, v11, v12
  v_lshlrev_b32 v13, 7, v4
  v_lshl_add_u32 v13, v6, 1, v13
  v_add_u32 v13, s68, v13
  v_mov_b32 v14, 0
  v_mov_b32 v15, s68
  v_cvt_pk_bf16_f32 v16, v176, v177
  v_cvt_pk_bf16_f32 v17, v178, v179
  v_cvt_pk_bf16_f32 v18, v180, v181
  v_cvt_pk_bf16_f32 v19, v182, v183
  v_cvt_pk_bf16_f32 v20, v184, v185
  v_cvt_pk_bf16_f32 v21, v186, v187
  ds_write_b64 v10, v[16:17] offset:16
  ds_write_b32 v11, v18 offset:16
  ds_write_b32 v12, v19 offset:16
  ds_write_b16 v13, v20 offset:1040
  ds_write_b16_d16_hi v13, v20 offset:1072
  ds_write_b16 v13, v21 offset:1104
  ds_write_b16_d16_hi v13, v21 offset:1136
  ds_write_b32 v15, v14 offset:12
  v_and_b32 v8, 31, v0
  v_lshl_add_u32 v9, v8, 4, s68
  v_lshl_add_u32 v10, v8, 3, s68
  v_min_u32 v11, 1, v8
  v_lshl_add_u32 v11, v11, 1, v10
  v_lshl_add_u32 v12, v0, 2, s68
  v_lshl_add_u32 v13, v0, 1, s68
  s_mul_i32 s69, s3, 8448
  s_add_u32 s69, s69, 55680
  v_lshl_add_u32 v14, v0, 4, s69
  v_mov_b32 v40, 0
  v_mov_b32 v41, 0
  v_mov_b32 v42, 0
  v_mov_b32 v43, 0
  s_waitcnt lgkmcnt(0)
  ds_read_b128 v[16:19], v9 offset:16
  ds_read_b32 v20, v9 offset:12
  ds_read_b64 v[22:23], v10 offset:528
  ds_read_b32 v24, v10 offset:536
  ds_read_u16 v25, v11 offset:526
  ds_read_b32 v26, v12 offset:784
  ds_read_b32 v27, v12 offset:788
  ds_read_u16 v28, v13 offset:1040
  ds_read_u16 v60, v13 offset:1042
  ds_read_u16 v29, v13 offset:1168
  ds_read_u16 v61, v13 offset:1170
  s_mov_b32 s70, 0xffff
  s_mov_b32 s71, 0x01000100
  s_mov_b32 s72, 0x03020302
  s_mov_b32 s75, 0x05040100
  v_and_b32 v30, 1, v0
  v_mul_u32_u24 v31, 0x0404, v30
  v_lshlrev_b32 v30, 16, v31
  v_add_u32 v30, 0x01000504, v30
  v_add_u32 v31, 0x01000100, v31
  s_mov_b64 exec, 0xff
  ds_write_b128 v14, v[40:43]
  ds_write_b128 v14, v[40:43] offset:4224
  s_mov_b64 exec, 0xffffffff
  s_waitcnt lgkmcnt(2)
  v_alignbit_b32 v32, v19, v19, 16
  v_alignbit_b32 v33, v18, v18, 16
  v_alignbit_b32 v34, v17, v17, 16
  v_alignbit_b32 v35, v16, v16, 16
  v_bfi_b32 v36, s70, v19, v18
  v_bfi_b32 v37, s70, v18, v17
  v_bfi_b32 v38, s70, v17, v16
  v_bfi_b32 v39, s70, v16, v20
  ds_write_b128 v14, v[32:35] offset:4352
  ds_write_b128 v14, v[36:39] offset:128
  v_bfi_b32 v44, s70, v24, v23
  v_perm_b32 v45, v23, v23, s71
  v_bfi_b32 v46, s70, v23, v22
  v_perm_b32 v47, v22, v22, s71
  v_alignbit_b32 v48, v23, v23, 16
  v_mov_b32 v49, v45
  v_alignbit_b32 v50, v22, v22, 16
  v_perm_b32 v51, v25, v22, s75
  ds_write_b128 v14, v[44:47] offset:4864
  ds_write_b128 v14, v[48:51] offset:640
  s_mov_b64 exec, -1
  v_perm_b32 v64, v27, v27, s71
  v_perm_b32 v65, v26, v26, s72
  v_alignbit_b32 v66, v26, v26, 16
  v_perm_b32 v67, v26, v26, s71
  v_bfi_b32 v68, s70, v27, v26
  v_mov_b32 v69, v65
  v_mov_b32 v70, v67
  v_mov_b32 v71, v67
  ds_write_b128 v14, v[64:67] offset:5376
  ds_write_b128 v14, v[68:71] offset:1152
  v_perm_b32 v72, v60, v60, s71
  v_perm_b32 v73, v60, v28, v30
  v_perm_b32 v74, v28, v28, s71
  v_perm_b32 v77, v60, v28, v31
  v_mov_b32 v75, v74
  v_mov_b32 v76, v72
  v_mov_b32 v78, v74
  v_mov_b32 v79, v74
  ds_write_b128 v14, v[72:75] offset:6400
  ds_write_b128 v14, v[76:79] offset:2176
  v_perm_b32 v80, v61, v61, s71
  v_perm_b32 v81, v61, v29, v30
  v_perm_b32 v82, v29, v29, s71
  v_perm_b32 v85, v61, v29, v31
  v_mov_b32 v83, v82
  v_mov_b32 v84, v80
  v_mov_b32 v86, v82
  v_mov_b32 v87, v82
  ds_write_b128 v14, v[80:83] offset:7424
  ds_write_b128 v14, v[84:87] offset:3200
  s_branch Lconv
Laux:
  s_and_b32 s55, s54, 7
  s_lshr_b32 s56, s54, 3
  s_setprio 1
  s_lshr_b32 s81, 0xfff, s56
  s_and_b32 s81, s81, 1
  v_lshrrev_b32 v4, 3, v0
  v_and_b32 v5, 7, v0
  s_cmp_eq_u32 s81, 0
  s_cbranch_scc1 Laux_nocs
  s_lshr_b32 s77, s55, 1
  s_and_b32 s78, s55, 1
  s_mul_i32 s78, s78, 12
  s_add_u32 s78, s78, s56
  v_mul_u32_u24 v8, 0xc00, v4
  v_lshl_add_u32 v8, v5, 4, v8
  s_mul_i32 s72, s77, 491520
  s_lshl_b32 s73, s78, 7
  s_add_u32 s72, s72, s73
  buffer_load_dwordx4 v[116:119], v8, s[8:11], s72 offen
  s_add_u32 s72, s72, 24576
  buffer_load_dwordx4 v[120:123], v8, s[8:11], s72 offen
  s_add_u32 s72, s72, 24576
  buffer_load_dwordx4 v[124:127], v8, s[8:11], s72 offen
  s_add_u32 s72, s72, 24576
  buffer_load_dwordx4 v[128:131], v8, s[8:11], s72 offen
  s_add_u32 s72, s72, 24576
  buffer_load_dwordx4 v[132:135], v8, s[8:11], s72 offen
  s_add_u32 s72, s72, 24576
  buffer_load_dwordx4 v[136:139], v8, s[8:11], s72 offen
  s_add_u32 s72, s72, 24576
  buffer_load_dwordx4 v[140:143], v8, s[8:11], s72 offen
  s_add_u32 s72, s72, 24576
  buffer_load_dwordx4 v[144:147], v8, s[8:11], s72 offen
  s_add_u32 s72, s72, 24576
  buffer_load_dwordx4 v[148:151], v8, s[8:11], s72 offen
  s_add_u32 s72, s72, 24576
  buffer_load_dwordx4 v[152:155], v8, s[8:11], s72 offen
  s_add_u32 s72, s72, 24576
  buffer_load_dwordx4 v[156:159], v8, s[8:11], s72 offen
  s_add_u32 s72, s72, 24576
  buffer_load_dwordx4 v[160:163], v8, s[8:11], s72 offen
  s_add_u32 s72, s72, 24576
  buffer_load_dwordx4 v[164:167], v8, s[8:11], s72 offen
  s_add_u32 s72, s72, 24576
  buffer_load_dwordx4 v[168:171], v8, s[8:11], s72 offen
  s_add_u32 s72, s72, 24576
  buffer_load_dwordx4 v[172:175], v8, s[8:11], s72 offen
  s_add_u32 s72, s72, 24576
  buffer_load_dwordx4 v[176:179], v8, s[8:11], s72 offen
  s_add_u32 s72, s72, 24576
  buffer_load_dwordx4 v[180:183], v8, s[8:11], s72 offen
  s_add_u32 s72, s72, 24576
  buffer_load_dwordx4 v[184:187], v8, s[8:11], s72 offen
  s_add_u32 s72, s72, 24576
  buffer_load_dwordx4 v[188:191], v8, s[8:11], s72 offen
  s_add_u32 s72, s72, 24576
  buffer_load_dwordx4 v[192:195], v8, s[8:11], s72 offen
Laux_nocs:
  s_lshl_b32 s68, s55, 8
  s_lshl_b32 s70, s56, 3
  s_add_u32 s68, s68, s70
  s_mul_i32 s70, s68, 1280
  v_mul_u32_u24 v1, 0x500, v4
  v_lshl_add_u32 v1, v5, 4, v1
  buffer_load_dwordx4 v[16:19], v1, s[4:7], s70 offen offset:0
  buffer_load_dwordx4 v[20:23], v1, s[4:7], s70 offen offset:128
  buffer_load_dwordx4 v[24:27], v1, s[4:7], s70 offen offset:256
  buffer_load_dwordx4 v[28:31], v1, s[4:7], s70 offen offset:384
  buffer_load_dwordx4 v[32:35], v1, s[4:7], s70 offen offset:512
  buffer_load_dwordx4 v[36:39], v1, s[4:7], s70 offen offset:640
  buffer_load_dwordx4 v[40:43], v1, s[4:7], s70 offen offset:768
  buffer_load_dwordx4 v[44:47], v1, s[4:7], s70 offen offset:896
  buffer_load_dwordx4 v[48:51], v1, s[4:7], s70 offen offset:1024
  buffer_load_dwordx4 v[52:55], v1, s[4:7], s70 offen offset:1152
  s_and_b32 s69, s55, 1
  s_mul_i32 s69, s69, 40
  s_add_u32 s69, s69, s56
  v_mul_u32_u24 v2, 10240, v5
  v_lshl_add_u32 v2, v4, 4, v2
  v_add_u32 v3, 3840, v2
  v_add_u32 v6, 7680, v2
  v_lshlrev_b32 v7, 15, v4
  v_lshl_add_u32 v7, v5, 4, v7
  s_mul_i32 s70, s69, 6554
  s_lshr_b32 s70, s70, 16
  s_mul_i32 s71, s70, 10
  s_sub_u32 s71, s69, s71
  s_lshr_b32 s72, s55, 1
  s_lshl_b32 s72, s72, 3
  s_add_u32 s70, s70, s72
  s_mul_i32 s73, s70, 81920
  s_lshl_b32 s72, s71, 7
  s_add_u32 s73, s73, s72
  s_lshl_b32 s79, s71, 18
  s_lshl_b32 s72, s70, 7
  s_add_u32 s79, s79, s72
  s_add_u32 s79, s79, 1048576
  buffer_load_dwordx4 v[56:59], v2, s[4:7], s73 offen offset:0
  buffer_load_dwordx4 v[60:63], v2, s[4:7], s73 offen offset:1280
  buffer_load_dwordx4 v[64:67], v2, s[4:7], s73 offen offset:2560
  buffer_load_dwordx4 v[68:71], v3, s[4:7], s73 offen offset:0
  buffer_load_dwordx4 v[72:75], v3, s[4:7], s73 offen offset:1280
  buffer_load_dwordx4 v[76:79], v3, s[4:7], s73 offen offset:2560
  buffer_load_dwordx4 v[80:83], v6, s[4:7], s73 offen offset:0
  buffer_load_dwordx4 v[84:87], v6, s[4:7], s73 offen offset:1280
  s_cmp_lt_u32 s56, 24
  s_cbranch_scc1 Laux_b1
  s_add_u32 s69, s69, 8
  s_mul_i32 s70, s69, 6554
  s_lshr_b32 s70, s70, 16
  s_mul_i32 s71, s70, 10
  s_sub_u32 s71, s69, s71
  s_lshr_b32 s72, s55, 1
  s_lshl_b32 s72, s72, 3
  s_add_u32 s70, s70, s72
  s_mul_i32 s73, s70, 81920
  s_lshl_b32 s72, s71, 7
  s_add_u32 s73, s73, s72
  s_lshl_b32 s80, s71, 18
  s_lshl_b32 s72, s70, 7
  s_add_u32 s80, s80, s72
  s_add_u32 s80, s80, 1048576
  buffer_load_dwordx4 v[212:215], v2, s[4:7], s73 offen offset:0
  buffer_load_dwordx4 v[216:219], v2, s[4:7], s73 offen offset:1280
  buffer_load_dwordx4 v[220:223], v2, s[4:7], s73 offen offset:2560
  buffer_load_dwordx4 v[224:227], v3, s[4:7], s73 offen offset:0
  buffer_load_dwordx4 v[228:231], v3, s[4:7], s73 offen offset:1280
  buffer_load_dwordx4 v[232:235], v3, s[4:7], s73 offen offset:2560
  buffer_load_dwordx4 v[236:239], v6, s[4:7], s73 offen offset:0
  buffer_load_dwordx4 v[240:243], v6, s[4:7], s73 offen offset:1280
Laux_b1:
  s_getpc_b64 s[62:63]
Lpc:
  s_sub_u32 s62, s62, Lpc-parallel_sum__ssm_conv_s4__dense_activation_mish__prompt_kernel
  s_subb_u32 s63, s63, 0
  v_min_u32 v8, 9, v0
  s_mul_i32 s70, s56, 10
  v_add_u32 v8, s70, v8
  v_lshlrev_b32 v8, 7, v8
  v_min_u32 v8, Lend-parallel_sum__ssm_conv_s4__dense_activation_mish__prompt_kernel, v8
  s_mov_b64 exec, 0x3ff
  global_load_dword v252, v8, s[62:63]
  s_mov_b64 exec, -1
  s_setprio 3
  s_waitcnt lgkmcnt(0)
  s_mul_i32 s52, s53, 0x9E3779B1
  s_add_u32 s52, s52, 0x7F4A7C15
  s_mov_b32 s74, 0x05040100
  s_mov_b32 s75, 0x07060302
  s_mov_b32 s70, 0x3f803f80
  v_and_b32 v8, 15, v0
  v_lshrrev_b32 v9, 1, v8
  v_and_b32 v10, 1, v8
  v_lshlrev_b32 v10, 4, v10
  v_mov_b32 v11, 0x3f80
  v_lshlrev_b32 v11, v10, v11
  v_cmp_eq_u32 vcc, 0, v9
  s_nop 1
  v_cndmask_b32 v88, 0, v11, vcc
  v_cmp_eq_u32 vcc, 1, v9
  s_nop 1
  v_cndmask_b32 v89, 0, v11, vcc
  v_cmp_eq_u32 vcc, 2, v9
  s_nop 1
  v_cndmask_b32 v90, 0, v11, vcc
  v_cmp_eq_u32 vcc, 3, v9
  s_nop 1
  v_cndmask_b32 v91, 0, v11, vcc
  s_lshl_b32 s76, s54, 7
  s_cmp_eq_u32 s81, 0
  s_cbranch_scc1 Laux_nocs1
  s_waitcnt vmcnt(19)
  v_mfma_f32_16x16x32_bf16 v[112:115], v[88:91], v[116:119], 0
  v_mfma_f32_16x16x32_bf16 v[112:115], v[88:91], v[120:123], v[112:115]
  v_mfma_f32_16x16x32_bf16 v[112:115], v[88:91], v[124:127], v[112:115]
  v_mfma_f32_16x16x32_bf16 v[112:115], v[88:91], v[128:131], v[112:115]
  v_mfma_f32_16x16x32_bf16 v[112:115], v[88:91], v[132:135], v[112:115]
  v_mfma_f32_16x16x32_bf16 v[112:115], v[88:91], v[136:139], v[112:115]
  v_mfma_f32_16x16x32_bf16 v[112:115], v[88:91], v[140:143], v[112:115]
  v_mfma_f32_16x16x32_bf16 v[112:115], v[88:91], v[144:147], v[112:115]
  v_mfma_f32_16x16x32_bf16 v[112:115], v[88:91], v[148:151], v[112:115]
  v_mfma_f32_16x16x32_bf16 v[112:115], v[88:91], v[152:155], v[112:115]
  v_mfma_f32_16x16x32_bf16 v[112:115], v[88:91], v[156:159], v[112:115]
  v_mfma_f32_16x16x32_bf16 v[112:115], v[88:91], v[160:163], v[112:115]
  v_mfma_f32_16x16x32_bf16 v[112:115], v[88:91], v[164:167], v[112:115]
  v_mfma_f32_16x16x32_bf16 v[112:115], v[88:91], v[168:171], v[112:115]
  v_mfma_f32_16x16x32_bf16 v[112:115], v[88:91], v[172:175], v[112:115]
  v_mfma_f32_16x16x32_bf16 v[112:115], v[88:91], v[176:179], v[112:115]
  v_mfma_f32_16x16x32_bf16 v[112:115], v[88:91], v[180:183], v[112:115]
  v_mfma_f32_16x16x32_bf16 v[112:115], v[88:91], v[184:187], v[112:115]
  v_mfma_f32_16x16x32_bf16 v[112:115], v[88:91], v[188:191], v[112:115]
  v_mfma_f32_16x16x32_bf16 v[112:115], v[88:91], v[192:195], v[112:115]
  s_nop 7
  v_add_f32_dpp v112, v112, v112 row_ror:8 row_mask:0xf bank_mask:0xf
  v_add_f32_dpp v113, v113, v113 row_ror:8 row_mask:0xf bank_mask:0xf
  v_add_f32_dpp v114, v114, v114 row_ror:8 row_mask:0xf bank_mask:0xf
  v_add_f32_dpp v115, v115, v115 row_ror:8 row_mask:0xf bank_mask:0xf
  v_lshrrev_b32 v9, 4, v0
  v_lshlrev_b32 v8, 5, v5
  v_lshl_add_u32 v8, v9, 4, v8
  s_lshl_b32 s72, s78, 8
  s_mul_i32 s73, s77, 6144
  s_add_u32 s72, s72, s73
  s_add_u32 s72, s72, 212992
  s_mov_b64 exec, 0x00ff00ff
  buffer_store_dwordx4 v[112:115], v8, s[12:15], s72 offen sc1
  s_mov_b64 exec, -1
  s_waitcnt vmcnt(10)
  s_branch Laux_w
Laux_nocs1:
  s_waitcnt vmcnt(17)
  s_cmp_ge_u32 s56, 24
  s_cbranch_scc1 Laux_w
  s_waitcnt vmcnt(9)
Laux_w:
  v_dot2_f32_bf16 v8, v16, s70, 0
  v_dot2_f32_bf16 v9, v17, s70, 0
  v_dot2_f32_bf16 v10, v18, s70, 0
  v_dot2_f32_bf16 v11, v19, s70, 0
  v_dot2_f32_bf16 v12, v16, v16, 0
  v_dot2_f32_bf16 v13, v17, v17, 0
  v_dot2_f32_bf16 v14, v18, v18, 0
  v_dot2_f32_bf16 v15, v19, v19, 0
  v_dot2_f32_bf16 v8, v20, s70, v8
  v_dot2_f32_bf16 v9, v21, s70, v9
  v_dot2_f32_bf16 v10, v22, s70, v10
  v_dot2_f32_bf16 v11, v23, s70, v11
  v_dot2_f32_bf16 v12, v20, v20, v12
  v_dot2_f32_bf16 v13, v21, v21, v13
  v_dot2_f32_bf16 v14, v22, v22, v14
  v_dot2_f32_bf16 v15, v23, v23, v15
  v_dot2_f32_bf16 v8, v24, s70, v8
  v_dot2_f32_bf16 v9, v25, s70, v9
  v_dot2_f32_bf16 v10, v26, s70, v10
  v_dot2_f32_bf16 v11, v27, s70, v11
  v_dot2_f32_bf16 v12, v24, v24, v12
  v_dot2_f32_bf16 v13, v25, v25, v13
  v_dot2_f32_bf16 v14, v26, v26, v14
  v_dot2_f32_bf16 v15, v27, v27, v15
  v_dot2_f32_bf16 v8, v28, s70, v8
  v_dot2_f32_bf16 v9, v29, s70, v9
  v_dot2_f32_bf16 v10, v30, s70, v10
  v_dot2_f32_bf16 v11, v31, s70, v11
  v_dot2_f32_bf16 v12, v28, v28, v12
  v_dot2_f32_bf16 v13, v29, v29, v13
  v_dot2_f32_bf16 v14, v30, v30, v14
  v_dot2_f32_bf16 v15, v31, v31, v15
  v_dot2_f32_bf16 v8, v32, s70, v8
  v_dot2_f32_bf16 v9, v33, s70, v9
  v_dot2_f32_bf16 v10, v34, s70, v10
  v_dot2_f32_bf16 v11, v35, s70, v11
  v_dot2_f32_bf16 v12, v32, v32, v12
  v_dot2_f32_bf16 v13, v33, v33, v13
  v_dot2_f32_bf16 v14, v34, v34, v14
  v_dot2_f32_bf16 v15, v35, v35, v15
  v_dot2_f32_bf16 v8, v36, s70, v8
  v_dot2_f32_bf16 v9, v37, s70, v9
  v_dot2_f32_bf16 v10, v38, s70, v10
  v_dot2_f32_bf16 v11, v39, s70, v11
  v_dot2_f32_bf16 v12, v36, v36, v12
  v_dot2_f32_bf16 v13, v37, v37, v13
  v_dot2_f32_bf16 v14, v38, v38, v14
  v_dot2_f32_bf16 v15, v39, v39, v15
  v_dot2_f32_bf16 v8, v40, s70, v8
  v_dot2_f32_bf16 v9, v41, s70, v9
  v_dot2_f32_bf16 v10, v42, s70, v10
  v_dot2_f32_bf16 v11, v43, s70, v11
  v_dot2_f32_bf16 v12, v40, v40, v12
  v_dot2_f32_bf16 v13, v41, v41, v13
  v_dot2_f32_bf16 v14, v42, v42, v14
  v_dot2_f32_bf16 v15, v43, v43, v15
  v_dot2_f32_bf16 v8, v44, s70, v8
  v_dot2_f32_bf16 v9, v45, s70, v9
  v_dot2_f32_bf16 v10, v46, s70, v10
  v_dot2_f32_bf16 v11, v47, s70, v11
  v_dot2_f32_bf16 v12, v44, v44, v12
  v_dot2_f32_bf16 v13, v45, v45, v13
  v_dot2_f32_bf16 v14, v46, v46, v14
  v_dot2_f32_bf16 v15, v47, v47, v15
  v_dot2_f32_bf16 v8, v48, s70, v8
  v_dot2_f32_bf16 v9, v49, s70, v9
  v_dot2_f32_bf16 v10, v50, s70, v10
  v_dot2_f32_bf16 v11, v51, s70, v11
  v_dot2_f32_bf16 v12, v48, v48, v12
  v_dot2_f32_bf16 v13, v49, v49, v13
  v_dot2_f32_bf16 v14, v50, v50, v14
  v_dot2_f32_bf16 v15, v51, v51, v15
  v_dot2_f32_bf16 v8, v52, s70, v8
  v_dot2_f32_bf16 v9, v53, s70, v9
  v_dot2_f32_bf16 v10, v54, s70, v10
  v_dot2_f32_bf16 v11, v55, s70, v11
  v_dot2_f32_bf16 v12, v52, v52, v12
  v_dot2_f32_bf16 v13, v53, v53, v13
  v_dot2_f32_bf16 v14, v54, v54, v14
  v_dot2_f32_bf16 v15, v55, v55, v15
  v_add_f32 v8, v8, v9
  v_add_f32 v12, v12, v13
  v_add_f32 v10, v10, v11
  v_add_f32 v14, v14, v15
  v_add_f32 v8, v8, v10
  v_add_f32 v12, v12, v14
  s_nop 0
  v_add_f32_dpp v8, v8, v8 quad_perm:[1,0,3,2] row_mask:0xf bank_mask:0xf
  v_add_f32_dpp v12, v12, v12 quad_perm:[1,0,3,2] row_mask:0xf bank_mask:0xf
  s_nop 0
  v_add_f32_dpp v8, v8, v8 quad_perm:[2,3,0,1] row_mask:0xf bank_mask:0xf
  v_add_f32_dpp v12, v12, v12 quad_perm:[2,3,0,1] row_mask:0xf bank_mask:0xf
  s_nop 0
  v_add_f32_dpp v8, v8, v8 row_half_mirror row_mask:0xf bank_mask:0xf
  v_add_f32_dpp v12, v12, v12 row_half_mirror row_mask:0xf bank_mask:0xf
  v_mul_f32 v8, 986500301, v8
  v_mul_f32 v12, 986500301, v12
  v_mul_f32 v9, v8, v8
  v_sub_f32 v12, v12, v9
  v_mul_f32 v10, 0x41800000, v12
  v_sub_f32 v8, 0, v8
  v_cmp_nle_f32 vcc, v9, v10
  s_nop 0
  s_cbranch_vccz Laux_var
  v_mov_b32 v9, v8
  v_lshlrev_b32 v96, 16, v16
  v_and_b32 v97, 0xffff0000, v16
  v_lshlrev_b32 v98, 16, v17
  v_and_b32 v99, 0xffff0000, v17
  v_lshlrev_b32 v100, 16, v18
  v_and_b32 v101, 0xffff0000, v18
  v_lshlrev_b32 v102, 16, v19
  v_and_b32 v103, 0xffff0000, v19
  v_pk_add_f32 v[96:97], v[96:97], v[8:9]
  v_pk_add_f32 v[98:99], v[98:99], v[8:9]
  v_pk_add_f32 v[100:101], v[100:101], v[8:9]
  v_pk_add_f32 v[102:103], v[102:103], v[8:9]
  v_pk_mul_f32 v[12:13], v[96:97], v[96:97]
  v_pk_mul_f32 v[14:15], v[98:99], v[98:99]
  v_pk_fma_f32 v[12:13], v[100:101], v[100:101], v[12:13]
  v_pk_fma_f32 v[14:15], v[102:103], v[102:103], v[14:15]
  v_lshlrev_b32 v104, 16, v20
  v_and_b32 v105, 0xffff0000, v20
  v_lshlrev_b32 v106, 16, v21
  v_and_b32 v107, 0xffff0000, v21
  v_lshlrev_b32 v108, 16, v22
  v_and_b32 v109, 0xffff0000, v22
  v_lshlrev_b32 v110, 16, v23
  v_and_b32 v111, 0xffff0000, v23
  v_pk_add_f32 v[104:105], v[104:105], v[8:9]
  v_pk_add_f32 v[106:107], v[106:107], v[8:9]
  v_pk_add_f32 v[108:109], v[108:109], v[8:9]
  v_pk_add_f32 v[110:111], v[110:111], v[8:9]
  v_pk_fma_f32 v[12:13], v[104:105], v[104:105], v[12:13]
  v_pk_fma_f32 v[14:15], v[106:107], v[106:107], v[14:15]
  v_pk_fma_f32 v[12:13], v[108:109], v[108:109], v[12:13]
  v_pk_fma_f32 v[14:15], v[110:111], v[110:111], v[14:15]
  v_lshlrev_b32 v96, 16, v24
  v_and_b32 v97, 0xffff0000, v24
  v_lshlrev_b32 v98, 16, v25
  v_and_b32 v99, 0xffff0000, v25
  v_lshlrev_b32 v100, 16, v26
  v_and_b32 v101, 0xffff0000, v26
  v_lshlrev_b32 v102, 16, v27
  v_and_b32 v103, 0xffff0000, v27
  v_pk_add_f32 v[96:97], v[96:97], v[8:9]
  v_pk_add_f32 v[98:99], v[98:99], v[8:9]
  v_pk_add_f32 v[100:101], v[100:101], v[8:9]
  v_pk_add_f32 v[102:103], v[102:103], v[8:9]
  v_pk_fma_f32 v[12:13], v[96:97], v[96:97], v[12:13]
  v_pk_fma_f32 v[14:15], v[98:99], v[98:99], v[14:15]
  v_pk_fma_f32 v[12:13], v[100:101], v[100:101], v[12:13]
  v_pk_fma_f32 v[14:15], v[102:103], v[102:103], v[14:15]
  v_lshlrev_b32 v104, 16, v28
  v_and_b32 v105, 0xffff0000, v28
  v_lshlrev_b32 v106, 16, v29
  v_and_b32 v107, 0xffff0000, v29
  v_lshlrev_b32 v108, 16, v30
  v_and_b32 v109, 0xffff0000, v30
  v_lshlrev_b32 v110, 16, v31
  v_and_b32 v111, 0xffff0000, v31
  v_pk_add_f32 v[104:105], v[104:105], v[8:9]
  v_pk_add_f32 v[106:107], v[106:107], v[8:9]
  v_pk_add_f32 v[108:109], v[108:109], v[8:9]
  v_pk_add_f32 v[110:111], v[110:111], v[8:9]
  v_pk_fma_f32 v[12:13], v[104:105], v[104:105], v[12:13]
  v_pk_fma_f32 v[14:15], v[106:107], v[106:107], v[14:15]
  v_pk_fma_f32 v[12:13], v[108:109], v[108:109], v[12:13]
  v_pk_fma_f32 v[14:15], v[110:111], v[110:111], v[14:15]
  v_lshlrev_b32 v96, 16, v32
  v_and_b32 v97, 0xffff0000, v32
  v_lshlrev_b32 v98, 16, v33
  v_and_b32 v99, 0xffff0000, v33
  v_lshlrev_b32 v100, 16, v34
  v_and_b32 v101, 0xffff0000, v34
  v_lshlrev_b32 v102, 16, v35
  v_and_b32 v103, 0xffff0000, v35
  v_pk_add_f32 v[96:97], v[96:97], v[8:9]
  v_pk_add_f32 v[98:99], v[98:99], v[8:9]
  v_pk_add_f32 v[100:101], v[100:101], v[8:9]
  v_pk_add_f32 v[102:103], v[102:103], v[8:9]
  v_pk_fma_f32 v[12:13], v[96:97], v[96:97], v[12:13]
  v_pk_fma_f32 v[14:15], v[98:99], v[98:99], v[14:15]
  v_pk_fma_f32 v[12:13], v[100:101], v[100:101], v[12:13]
  v_pk_fma_f32 v[14:15], v[102:103], v[102:103], v[14:15]
  v_lshlrev_b32 v104, 16, v36
  v_and_b32 v105, 0xffff0000, v36
  v_lshlrev_b32 v106, 16, v37
  v_and_b32 v107, 0xffff0000, v37
  v_lshlrev_b32 v108, 16, v38
  v_and_b32 v109, 0xffff0000, v38
  v_lshlrev_b32 v110, 16, v39
  v_and_b32 v111, 0xffff0000, v39
  v_pk_add_f32 v[104:105], v[104:105], v[8:9]
  v_pk_add_f32 v[106:107], v[106:107], v[8:9]
  v_pk_add_f32 v[108:109], v[108:109], v[8:9]
  v_pk_add_f32 v[110:111], v[110:111], v[8:9]
  v_pk_fma_f32 v[12:13], v[104:105], v[104:105], v[12:13]
  v_pk_fma_f32 v[14:15], v[106:107], v[106:107], v[14:15]
  v_pk_fma_f32 v[12:13], v[108:109], v[108:109], v[12:13]
  v_pk_fma_f32 v[14:15], v[110:111], v[110:111], v[14:15]
  v_lshlrev_b32 v96, 16, v40
  v_and_b32 v97, 0xffff0000, v40
  v_lshlrev_b32 v98, 16, v41
  v_and_b32 v99, 0xffff0000, v41
  v_lshlrev_b32 v100, 16, v42
  v_and_b32 v101, 0xffff0000, v42
  v_lshlrev_b32 v102, 16, v43
  v_and_b32 v103, 0xffff0000, v43
  v_pk_add_f32 v[96:97], v[96:97], v[8:9]
  v_pk_add_f32 v[98:99], v[98:99], v[8:9]
  v_pk_add_f32 v[100:101], v[100:101], v[8:9]
  v_pk_add_f32 v[102:103], v[102:103], v[8:9]
  v_pk_fma_f32 v[12:13], v[96:97], v[96:97], v[12:13]
  v_pk_fma_f32 v[14:15], v[98:99], v[98:99], v[14:15]
  v_pk_fma_f32 v[12:13], v[100:101], v[100:101], v[12:13]
  v_pk_fma_f32 v[14:15], v[102:103], v[102:103], v[14:15]
  v_lshlrev_b32 v104, 16, v44
  v_and_b32 v105, 0xffff0000, v44
  v_lshlrev_b32 v106, 16, v45
  v_and_b32 v107, 0xffff0000, v45
  v_lshlrev_b32 v108, 16, v46
  v_and_b32 v109, 0xffff0000, v46
  v_lshlrev_b32 v110, 16, v47
  v_and_b32 v111, 0xffff0000, v47
  v_pk_add_f32 v[104:105], v[104:105], v[8:9]
  v_pk_add_f32 v[106:107], v[106:107], v[8:9]
  v_pk_add_f32 v[108:109], v[108:109], v[8:9]
  v_pk_add_f32 v[110:111], v[110:111], v[8:9]
  v_pk_fma_f32 v[12:13], v[104:105], v[104:105], v[12:13]
  v_pk_fma_f32 v[14:15], v[106:107], v[106:107], v[14:15]
  v_pk_fma_f32 v[12:13], v[108:109], v[108:109], v[12:13]
  v_pk_fma_f32 v[14:15], v[110:111], v[110:111], v[14:15]
  v_lshlrev_b32 v96, 16, v48
  v_and_b32 v97, 0xffff0000, v48
  v_lshlrev_b32 v98, 16, v49
  v_and_b32 v99, 0xffff0000, v49
  v_lshlrev_b32 v100, 16, v50
  v_and_b32 v101, 0xffff0000, v50
  v_lshlrev_b32 v102, 16, v51
  v_and_b32 v103, 0xffff0000, v51
  v_pk_add_f32 v[96:97], v[96:97], v[8:9]
  v_pk_add_f32 v[98:99], v[98:99], v[8:9]
  v_pk_add_f32 v[100:101], v[100:101], v[8:9]
  v_pk_add_f32 v[102:103], v[102:103], v[8:9]
  v_pk_fma_f32 v[12:13], v[96:97], v[96:97], v[12:13]
  v_pk_fma_f32 v[14:15], v[98:99], v[98:99], v[14:15]
  v_pk_fma_f32 v[12:13], v[100:101], v[100:101], v[12:13]
  v_pk_fma_f32 v[14:15], v[102:103], v[102:103], v[14:15]
  v_lshlrev_b32 v104, 16, v52
  v_and_b32 v105, 0xffff0000, v52
  v_lshlrev_b32 v106, 16, v53
  v_and_b32 v107, 0xffff0000, v53
  v_lshlrev_b32 v108, 16, v54
  v_and_b32 v109, 0xffff0000, v54
  v_lshlrev_b32 v110, 16, v55
  v_and_b32 v111, 0xffff0000, v55
  v_pk_add_f32 v[104:105], v[104:105], v[8:9]
  v_pk_add_f32 v[106:107], v[106:107], v[8:9]
  v_pk_add_f32 v[108:109], v[108:109], v[8:9]
  v_pk_add_f32 v[110:111], v[110:111], v[8:9]
  v_pk_fma_f32 v[12:13], v[104:105], v[104:105], v[12:13]
  v_pk_fma_f32 v[14:15], v[106:107], v[106:107], v[14:15]
  v_pk_fma_f32 v[12:13], v[108:109], v[108:109], v[12:13]
  v_pk_fma_f32 v[14:15], v[110:111], v[110:111], v[14:15]
  v_add_f32 v12, v12, v13
  v_add_f32 v14, v14, v15
  v_add_f32 v12, v12, v14
  s_nop 1
  v_add_f32_dpp v12, v12, v12 quad_perm:[1,0,3,2] row_mask:0xf bank_mask:0xf
  s_nop 1
  v_add_f32_dpp v12, v12, v12 quad_perm:[2,3,0,1] row_mask:0xf bank_mask:0xf
  s_nop 1
  v_add_f32_dpp v12, v12, v12 row_half_mirror row_mask:0xf bank_mask:0xf
  v_mul_f32 v12, 986500301, v12
Laux_var:
  v_cvt_pk_bf16_f32 v9, v12, v12
  v_and_b32 v9, 0xffff0000, v9
  v_add_f32 v9, 0x3727C5AC, v9
  v_cvt_pk_bf16_f32 v9, v9, v9
  v_and_b32 v9, 0xffff0000, v9
  v_sqrt_f32 v9, v9
  s_nop 0
  v_cvt_pk_bf16_f32 v9, v8, v9
  v_lshlrev_b32 v12, 2, v4
  s_lshl_b32 s70, s68, 2
  s_add_u32 s70, s70, 196608
  s_mov_b32 exec_lo, 0x01010101
  s_mov_b32 exec_hi, 0x01010101
  buffer_store_dword v9, v12, s[12:15], s70 offen sc1
  s_mov_b64 exec, -1
  s_waitcnt vmcnt(1)
  v_perm_b32 v116, v60, v56, s74
  v_perm_b32 v117, v68, v64, s74
  v_perm_b32 v118, v76, v72, s74
  v_perm_b32 v119, v84, v80, s74
  v_perm_b32 v120, v60, v56, s75
  v_perm_b32 v121, v68, v64, s75
  v_perm_b32 v122, v76, v72, s75
  v_perm_b32 v123, v84, v80, s75
  v_perm_b32 v124, v61, v57, s74
  v_perm_b32 v125, v69, v65, s74
  v_perm_b32 v126, v77, v73, s74
  v_perm_b32 v127, v85, v81, s74
  v_perm_b32 v128, v61, v57, s75
  v_perm_b32 v129, v69, v65, s75
  v_perm_b32 v130, v77, v73, s75
  v_perm_b32 v131, v85, v81, s75
  v_perm_b32 v132, v62, v58, s74
  v_perm_b32 v133, v70, v66, s74
  v_perm_b32 v134, v78, v74, s74
  v_perm_b32 v135, v86, v82, s74
  v_perm_b32 v136, v62, v58, s75
  v_perm_b32 v137, v70, v66, s75
  v_perm_b32 v138, v78, v74, s75
  v_perm_b32 v139, v86, v82, s75
  v_perm_b32 v140, v63, v59, s74
  v_perm_b32 v141, v71, v67, s74
  v_perm_b32 v142, v79, v75, s74
  v_perm_b32 v143, v87, v83, s74
  v_perm_b32 v144, v63, v59, s75
  v_perm_b32 v145, v71, v67, s75
  v_perm_b32 v146, v79, v75, s75
  v_perm_b32 v147, v87, v83, s75
  s_add_u32 s70, s76, 32768
  s_waitcnt vmcnt(0)
  v_mov_b32 v8, s52
  v_mov_b32 v9, 0
  s_mov_b64 exec, 1
  buffer_store_dword v8, v9, s[12:15], s70 offen sc1
  s_mov_b64 exec, -1
  s_mov_b32 s48, s40
  s_mov_b32 s49, s41
  s_mov_b32 s50, 1966080
  s_mov_b32 s51, 0x20000
  s_add_u32 s70, s56, -12
  s_cmp_ge_u32 s70, 16
  s_cbranch_scc1 Laux_now1
  s_lshl_b32 s71, s55, 4
  s_add_u32 s70, s70, s71
  s_mul_i32 s71, s70, 15360
  s_mul_i32 s77, s70, 1920
  s_add_u32 s77, s77, 7340032
  s_lshl_b32 s78, s70, 7
  s_add_u32 s78, s78, 425984
  v_mul_u32_u24 v10, 6554, v0
  v_lshrrev_b32 v10, 16, v10
  v_mul_u32_u24 v11, 10, v10
  v_sub_u32 v11, v0, v11
  v_mul_u32_u24 v10, 0x500, v10
  v_lshl_add_u32 v10, v11, 4, v10
  v_add_u32 v12, 64, v0
  v_mul_u32_u24 v13, 6554, v12
  v_lshrrev_b32 v13, 16, v13
  v_mul_u32_u24 v11, 10, v13
  v_sub_u32 v11, v12, v11
  v_mul_u32_u24 v13, 0x500, v13
  v_lshl_add_u32 v11, v11, 4, v13
  buffer_load_dwordx4 v[148:151], v10, s[48:51], s71 offen offset:0
  buffer_load_dwordx4 v[156:159], v10, s[48:51], s71 offen offset:160
  buffer_load_dwordx4 v[164:167], v10, s[48:51], s71 offen offset:320
  buffer_load_dwordx4 v[172:175], v10, s[48:51], s71 offen offset:480
  buffer_load_dwordx4 v[180:183], v10, s[48:51], s71 offen offset:640
  buffer_load_dwordx4 v[188:191], v10, s[48:51], s71 offen offset:800
  buffer_load_dwordx4 v[196:199], v10, s[48:51], s71 offen offset:960
  buffer_load_dwordx4 v[204:207], v10, s[48:51], s71 offen offset:1120
  s_mov_b32 exec_hi, 0x00ffffff
  buffer_load_dwordx4 v[152:155], v11, s[48:51], s71 offen offset:0
  buffer_load_dwordx4 v[160:163], v11, s[48:51], s71 offen offset:160
  buffer_load_dwordx4 v[168:171], v11, s[48:51], s71 offen offset:320
  buffer_load_dwordx4 v[176:179], v11, s[48:51], s71 offen offset:480
  buffer_load_dwordx4 v[184:187], v11, s[48:51], s71 offen offset:640
  buffer_load_dwordx4 v[192:195], v11, s[48:51], s71 offen offset:800
  buffer_load_dwordx4 v[200:203], v11, s[48:51], s71 offen offset:960
  buffer_load_dwordx4 v[208:211], v11, s[48:51], s71 offen offset:1120
  s_mov_b64 exec, -1
Laux_now1:
  buffer_store_dwordx4 v[116:119], v7, s[12:15], s79 offen sc1
  s_add_u32 s79, s79, 4096
  buffer_store_dwordx4 v[120:123], v7, s[12:15], s79 offen sc1
  s_add_u32 s79, s79, 4096
  buffer_store_dwordx4 v[124:127], v7, s[12:15], s79 offen sc1
  s_add_u32 s79, s79, 4096
  buffer_store_dwordx4 v[128:131], v7, s[12:15], s79 offen sc1
  s_add_u32 s79, s79, 4096
  buffer_store_dwordx4 v[132:135], v7, s[12:15], s79 offen sc1
  s_add_u32 s79, s79, 4096
  buffer_store_dwordx4 v[136:139], v7, s[12:15], s79 offen sc1
  s_add_u32 s79, s79, 4096
  buffer_store_dwordx4 v[140:143], v7, s[12:15], s79 offen sc1
  s_add_u32 s79, s79, 4096
  buffer_store_dwordx4 v[144:147], v7, s[12:15], s79 offen sc1
  s_cmp_lt_u32 s56, 24
  s_cbranch_scc1 Laux_b2
  v_perm_b32 v244, v216, v212, s74
  v_perm_b32 v245, v224, v220, s74
  v_perm_b32 v246, v232, v228, s74
  v_perm_b32 v247, v240, v236, s74
  buffer_store_dwordx4 v[244:247], v7, s[12:15], s80 offen sc1
  s_add_u32 s80, s80, 4096
  v_perm_b32 v248, v216, v212, s75
  v_perm_b32 v249, v224, v220, s75
  v_perm_b32 v250, v232, v228, s75
  v_perm_b32 v251, v240, v236, s75
  buffer_store_dwordx4 v[248:251], v7, s[12:15], s80 offen sc1
  s_add_u32 s80, s80, 4096
  v_perm_b32 v244, v217, v213, s74
  v_perm_b32 v245, v225, v221, s74
  v_perm_b32 v246, v233, v229, s74
  v_perm_b32 v247, v241, v237, s74
  buffer_store_dwordx4 v[244:247], v7, s[12:15], s80 offen sc1
  s_add_u32 s80, s80, 4096
  v_perm_b32 v248, v217, v213, s75
  v_perm_b32 v249, v225, v221, s75
  v_perm_b32 v250, v233, v229, s75
  v_perm_b32 v251, v241, v237, s75
  buffer_store_dwordx4 v[248:251], v7, s[12:15], s80 offen sc1
  s_add_u32 s80, s80, 4096
  v_perm_b32 v244, v218, v214, s74
  v_perm_b32 v245, v226, v222, s74
  v_perm_b32 v246, v234, v230, s74
  v_perm_b32 v247, v242, v238, s74
  buffer_store_dwordx4 v[244:247], v7, s[12:15], s80 offen sc1
  s_add_u32 s80, s80, 4096
  v_perm_b32 v248, v218, v214, s75
  v_perm_b32 v249, v226, v222, s75
  v_perm_b32 v250, v234, v230, s75
  v_perm_b32 v251, v242, v238, s75
  buffer_store_dwordx4 v[248:251], v7, s[12:15], s80 offen sc1
  s_add_u32 s80, s80, 4096
  v_perm_b32 v244, v219, v215, s74
  v_perm_b32 v245, v227, v223, s74
  v_perm_b32 v246, v235, v231, s74
  v_perm_b32 v247, v243, v239, s74
  buffer_store_dwordx4 v[244:247], v7, s[12:15], s80 offen sc1
  s_add_u32 s80, s80, 4096
  v_perm_b32 v248, v219, v215, s75
  v_perm_b32 v249, v227, v223, s75
  v_perm_b32 v250, v235, v231, s75
  v_perm_b32 v251, v243, v239, s75
  buffer_store_dwordx4 v[248:251], v7, s[12:15], s80 offen sc1
Laux_b2:
  s_add_u32 s70, s76, 458752
  s_waitcnt vmcnt(0)
  v_mov_b32 v8, s52
  v_mov_b32 v9, 0
  s_mov_b64 exec, 1
  buffer_store_dword v8, v9, s[12:15], s70 offen sc1
  s_mov_b64 exec, -1
  s_add_u32 s70, s56, -12
  s_cmp_ge_u32 s70, 16
  s_cbranch_scc1 Laux_now2
  v_lshlrev_b32 v8, 4, v0
  buffer_store_dwordx4 v[148:151], v8, s[12:15], s77 offen sc1
  s_mov_b32 exec_hi, 0x00ffffff
  buffer_store_dwordx4 v[152:155], v8, s[12:15], s77 offen offset:1024 sc1
  s_mov_b32 exec_hi, -1
  s_add_u32 s77, s77, 245760
  buffer_store_dwordx4 v[156:159], v8, s[12:15], s77 offen sc1
  s_mov_b32 exec_hi, 0x00ffffff
  buffer_store_dwordx4 v[160:163], v8, s[12:15], s77 offen offset:1024 sc1
  s_mov_b32 exec_hi, -1
  s_add_u32 s77, s77, 245760
  buffer_store_dwordx4 v[164:167], v8, s[12:15], s77 offen sc1
  s_mov_b32 exec_hi, 0x00ffffff
  buffer_store_dwordx4 v[168:171], v8, s[12:15], s77 offen offset:1024 sc1
  s_mov_b32 exec_hi, -1
  s_add_u32 s77, s77, 245760
  buffer_store_dwordx4 v[172:175], v8, s[12:15], s77 offen sc1
  s_mov_b32 exec_hi, 0x00ffffff
  buffer_store_dwordx4 v[176:179], v8, s[12:15], s77 offen offset:1024 sc1
  s_mov_b32 exec_hi, -1
  s_add_u32 s77, s77, 245760
  buffer_store_dwordx4 v[180:183], v8, s[12:15], s77 offen sc1
  s_mov_b32 exec_hi, 0x00ffffff
  buffer_store_dwordx4 v[184:187], v8, s[12:15], s77 offen offset:1024 sc1
  s_mov_b32 exec_hi, -1
  s_add_u32 s77, s77, 245760
  buffer_store_dwordx4 v[188:191], v8, s[12:15], s77 offen sc1
  s_mov_b32 exec_hi, 0x00ffffff
  buffer_store_dwordx4 v[192:195], v8, s[12:15], s77 offen offset:1024 sc1
  s_mov_b32 exec_hi, -1
  s_add_u32 s77, s77, 245760
  buffer_store_dwordx4 v[196:199], v8, s[12:15], s77 offen sc1
  s_mov_b32 exec_hi, 0x00ffffff
  buffer_store_dwordx4 v[200:203], v8, s[12:15], s77 offen offset:1024 sc1
  s_mov_b32 exec_hi, -1
  s_add_u32 s77, s77, 245760
  buffer_store_dwordx4 v[204:207], v8, s[12:15], s77 offen sc1
  s_mov_b32 exec_hi, 0x00ffffff
  buffer_store_dwordx4 v[208:211], v8, s[12:15], s77 offen offset:1024 sc1
  s_mov_b32 exec_hi, -1
  s_waitcnt vmcnt(0)
  v_mov_b32 v8, s52
  v_mov_b32 v9, 0
  s_mov_b64 exec, 1
  buffer_store_dword v8, v9, s[12:15], s78 offen sc1
  s_mov_b64 exec, -1
Laux_now2:
  s_cmp_lg_u32 s56, 31
  s_cbranch_scc1 Laux_go
  v_mul_u32_u24 v24, 128, v0
  s_mov_b32 s72, 458752
  s_mov_b32 s73, 466944
  s_mov_b32 s74, 475136
  s_mov_b32 s75, 483328
  buffer_load_dword v20, v24, s[12:15], s72 offen sc1
  buffer_load_dword v21, v24, s[12:15], s73 offen sc1
  buffer_load_dword v22, v24, s[12:15], s74 offen sc1
  buffer_load_dword v23, v24, s[12:15], s75 offen sc1
  s_waitcnt vmcnt(0)
  v_cmp_ne_u32 s[66:67], s52, v23
  v_cmp_ne_u32 s[64:65], s52, v22
  v_cmp_ne_u32 s[62:63], s52, v21
  v_cmp_ne_u32 vcc, s52, v20
  s_nop 0
  s_or_b64 vcc, vcc, s[62:63]
  s_or_b64 vcc, vcc, s[64:65]
  s_or_b64 vcc, vcc, s[66:67]
  s_cmp_eq_u64 vcc, 0
  s_cbranch_scc1 Lok_22
  s_mov_b32 s60, 20000
Lspin_21:
  s_sleep 1
  buffer_load_dword v20, v24, s[12:15], s72 offen sc1
  buffer_load_dword v21, v24, s[12:15], s73 offen sc1
  buffer_load_dword v22, v24, s[12:15], s74 offen sc1
  buffer_load_dword v23, v24, s[12:15], s75 offen sc1
  s_waitcnt vmcnt(0)
  v_cmp_ne_u32 s[66:67], s52, v23
  v_cmp_ne_u32 s[64:65], s52, v22
  v_cmp_ne_u32 s[62:63], s52, v21
  v_cmp_ne_u32 vcc, s52, v20
  s_nop 0
  s_or_b64 vcc, vcc, s[62:63]
  s_or_b64 vcc, vcc, s[64:65]
  s_or_b64 vcc, vcc, s[66:67]
  s_cmp_eq_u64 vcc, 0
  s_cbranch_scc1 Lok_22
  s_sub_u32 s60, s60, 1
  s_cmp_lg_u32 s60, 0
  s_cbranch_scc1 Lspin_21
Lok_22:
  s_lshl_b32 s70, s55, 7
  s_add_u32 s70, s70, 4096
  v_mov_b32 v8, s52
  v_mov_b32 v9, 0
  s_mov_b64 exec, 1
  buffer_store_dword v8, v9, s[12:15], s70 offen sc1
  s_mov_b64 exec, -1
Laux_go:
  s_setprio 1
  v_mov_b32 v21, 0
  s_and_b32 s75, s2, 7
  s_lshl_b32 s75, s75, 7
  s_add_u32 s75, s75, 4096
  buffer_load_dword v20, v21, s[12:15], s75 offen sc1
  s_waitcnt vmcnt(0)
  v_cmp_ne_u32 vcc, s52, v20
  s_nop 0
  s_cmp_eq_u64 vcc, 0
  s_cbranch_scc1 Lok_24
  s_mov_b32 s60, 20000
Lspin_23:
  s_sleep 3
  buffer_load_dword v20, v21, s[12:15], s75 offen sc1
  s_waitcnt vmcnt(0)
  v_cmp_ne_u32 vcc, s52, v20
  s_nop 0
  s_cmp_eq_u64 vcc, 0
  s_cbranch_scc1 Lok_24
  s_sub_u32 s60, s60, 1
  s_cmp_lg_u32 s60, 0
  s_cbranch_scc1 Lspin_23
Lok_24:
  v_lshlrev_b32 v224, 4, v0
  s_lshl_b32 s70, s3, 10
  v_add_u32 v224, s70, v224
  v_lshlrev_b32 v225, 1, v224
  s_mov_b32 s70, 196608
  buffer_load_dwordx4 v[200:203], v225, s[12:15], s70 offen sc1
  buffer_load_dwordx4 v[204:207], v225, s[12:15], s70 offen offset:16 sc1
  s_lshl_b32 s70, s58, 12
  s_add_u32 s70, s70, 1048576
  buffer_load_dwordx4 v[208:211], v224, s[12:15], s70 offen sc1
  s_lshl_b32 s70, s59, 12
  s_add_u32 s70, s70, 1048576
  buffer_load_dwordx4 v[212:215], v224, s[12:15], s70 offen sc1
  s_lshl_b32 s70, s61, 12
  s_add_u32 s70, s70, 1048576
  buffer_load_dwordx4 v[216:219], v224, s[12:15], s70 offen sc1
Lconv:
  v_and_b32 v10, 15, v0
  v_lshrrev_b32 v11, 4, v0
  v_and_b32 v12, 1, v0
  v_lshrrev_b32 v13, 1, v10
  v_mul_u32_u24 v14, 4224, v12
  v_sub_u32 v15, v13, v11
  v_lshl_add_u32 v14, v15, 4, v14
  v_add_u32 v14, 55744, v14
  v_and_b32 v12, 3, v0
  v_mul_u32_u24 v15, 4640, v12
  v_lshrrev_b32 v13, 2, v10
  v_lshl_add_u32 v15, v13, 7, v15
  v_lshl_add_u32 v15, v11, 4, v15
  v_add_u32 v15, 496, v15
  v_lshlrev_b32 v19, 7, v13
  v_lshl_add_u32 v19, v11, 5, v19
  v_lshl_add_u32 v19, v12, 2, v19
  v_mov_b32 v4, 0
  v_mov_b32 v5, 0
  v_lshlrev_b32 v6, 3, v0
  s_mul_i32 s70, s3, 4640
  v_add_u32 v6, s70, v6
  s_waitcnt lgkmcnt(0)
  s_barrier
  s_mov_b32 exec_hi, 0x00ffffff
  ds_write_b64 v6, v[4:5] offset:0
  ds_write_b64 v6, v[4:5] offset:18560
  ds_write_b64 v6, v[4:5] offset:37120
  s_mov_b32 exec_hi, -1
  s_waitcnt vmcnt(0)
  v_and_b32 v52, 0xffff0000, v200
  v_and_b32 v53, 0xffff0000, v201
  v_and_b32 v54, 0xffff0000, v202
  v_and_b32 v55, 0xffff0000, v203
  v_and_b32 v56, 0xffff0000, v204
  v_and_b32 v57, 0xffff0000, v205
  v_and_b32 v58, 0xffff0000, v206
  v_and_b32 v59, 0xffff0000, v207
  v_rcp_f32 v52, v52
  v_lshlrev_b32 v44, 16, v200
  v_rcp_f32 v53, v53
  v_lshlrev_b32 v45, 16, v201
  v_rcp_f32 v54, v54
  v_lshlrev_b32 v46, 16, v202
  v_rcp_f32 v55, v55
  v_lshlrev_b32 v47, 16, v203
  v_rcp_f32 v56, v56
  v_lshlrev_b32 v48, 16, v204
  v_rcp_f32 v57, v57
  v_lshlrev_b32 v49, 16, v205
  v_rcp_f32 v58, v58
  v_lshlrev_b32 v50, 16, v206
  v_rcp_f32 v59, v59
  v_lshlrev_b32 v51, 16, v207
  s_waitcnt lgkmcnt(0)
  s_barrier
  v_lshlrev_b32 v60, 16, v208
  v_and_b32 v61, 0xffff0000, v208
  v_lshlrev_b32 v62, 16, v209
  v_and_b32 v63, 0xffff0000, v209
  v_lshlrev_b32 v64, 16, v210
  v_and_b32 v65, 0xffff0000, v210
  v_lshlrev_b32 v66, 16, v211
  v_and_b32 v67, 0xffff0000, v211
  v_pk_add_f32 v[60:61], v[60:61], v[44:45]
  v_pk_add_f32 v[62:63], v[62:63], v[46:47]
  v_pk_add_f32 v[64:65], v[64:65], v[48:49]
  v_pk_add_f32 v[66:67], v[66:67], v[50:51]
  v_cvt_pk_bf16_f32 v208, v60, v61
  v_cvt_pk_bf16_f32 v209, v62, v63
  v_cvt_pk_bf16_f32 v210, v64, v65
  v_cvt_pk_bf16_f32 v211, v66, v67
  v_lshlrev_b32 v60, 16, v208
  v_and_b32 v61, 0xffff0000, v208
  v_lshlrev_b32 v62, 16, v209
  v_and_b32 v63, 0xffff0000, v209
  v_lshlrev_b32 v64, 16, v210
  v_and_b32 v65, 0xffff0000, v210
  v_lshlrev_b32 v66, 16, v211
  v_and_b32 v67, 0xffff0000, v211
  v_pk_mul_f32 v[60:61], v[60:61], v[52:53]
  v_pk_mul_f32 v[62:63], v[62:63], v[54:55]
  v_pk_mul_f32 v[64:65], v[64:65], v[56:57]
  v_pk_mul_f32 v[66:67], v[66:67], v[58:59]
  v_cvt_pk_bf16_f32 v208, v60, v61
  v_cvt_pk_bf16_f32 v209, v62, v63
  v_cvt_pk_bf16_f32 v210, v64, v65
  v_cvt_pk_bf16_f32 v211, v66, v67
  v_cvt_pk_bf16_f32 v68, v62, v63
  v_cvt_pk_bf16_f32 v69, v64, v65
  ds_write_b128 v224, v[208:211] offset:14352
  ds_write_b64 v224, v[208:209] offset:5080
  ds_write_b64 v224, v[210:211] offset:5088
  ds_write_b32 v224, v208 offset:444
  ds_write_b64 v224, v[68:69] offset:448
  ds_write_b32 v224, v211 offset:456
  ds_write_b32 v224, v208 offset:9716
  ds_write_b64 v224, v[68:69] offset:9720
  ds_write_b32 v224, v211 offset:9728
  v_lshlrev_b32 v60, 16, v212
  v_and_b32 v61, 0xffff0000, v212
  v_lshlrev_b32 v62, 16, v213
  v_and_b32 v63, 0xffff0000, v213
  v_lshlrev_b32 v64, 16, v214
  v_and_b32 v65, 0xffff0000, v214
  v_lshlrev_b32 v66, 16, v215
  v_and_b32 v67, 0xffff0000, v215
  v_pk_add_f32 v[60:61], v[60:61], v[44:45]
  v_pk_add_f32 v[62:63], v[62:63], v[46:47]
  v_pk_add_f32 v[64:65], v[64:65], v[48:49]
  v_pk_add_f32 v[66:67], v[66:67], v[50:51]
  v_cvt_pk_bf16_f32 v212, v60, v61
  v_cvt_pk_bf16_f32 v213, v62, v63
  v_cvt_pk_bf16_f32 v214, v64, v65
  v_cvt_pk_bf16_f32 v215, v66, v67
  v_lshlrev_b32 v60, 16, v212
  v_and_b32 v61, 0xffff0000, v212
  v_lshlrev_b32 v62, 16, v213
  v_and_b32 v63, 0xffff0000, v213
  v_lshlrev_b32 v64, 16, v214
  v_and_b32 v65, 0xffff0000, v214
  v_lshlrev_b32 v66, 16, v215
  v_and_b32 v67, 0xffff0000, v215
  v_pk_mul_f32 v[60:61], v[60:61], v[52:53]
  v_pk_mul_f32 v[62:63], v[62:63], v[54:55]
  v_pk_mul_f32 v[64:65], v[64:65], v[56:57]
  v_pk_mul_f32 v[66:67], v[66:67], v[58:59]
  v_cvt_pk_bf16_f32 v212, v60, v61
  v_cvt_pk_bf16_f32 v213, v62, v63
  v_cvt_pk_bf16_f32 v214, v64, v65
  v_cvt_pk_bf16_f32 v215, v66, v67
  v_cvt_pk_bf16_f32 v70, v62, v63
  v_cvt_pk_bf16_f32 v71, v64, v65
  ds_write_b128 v224, v[212:215] offset:32912
  ds_write_b64 v224, v[212:213] offset:23640
  ds_write_b64 v224, v[214:215] offset:23648
  ds_write_b32 v224, v212 offset:19004
  ds_write_b64 v224, v[70:71] offset:19008
  ds_write_b32 v224, v215 offset:19016
  ds_write_b32 v224, v212 offset:28276
  ds_write_b64 v224, v[70:71] offset:28280
  ds_write_b32 v224, v215 offset:28288
  v_lshlrev_b32 v60, 16, v216
  v_and_b32 v61, 0xffff0000, v216
  v_lshlrev_b32 v62, 16, v217
  v_and_b32 v63, 0xffff0000, v217
  v_lshlrev_b32 v64, 16, v218
  v_and_b32 v65, 0xffff0000, v218
  v_lshlrev_b32 v66, 16, v219
  v_and_b32 v67, 0xffff0000, v219
  v_pk_add_f32 v[60:61], v[60:61], v[44:45]
  v_pk_add_f32 v[62:63], v[62:63], v[46:47]
  v_pk_add_f32 v[64:65], v[64:65], v[48:49]
  v_pk_add_f32 v[66:67], v[66:67], v[50:51]
  v_cvt_pk_bf16_f32 v216, v60, v61
  v_cvt_pk_bf16_f32 v217, v62, v63
  v_cvt_pk_bf16_f32 v218, v64, v65
  v_cvt_pk_bf16_f32 v219, v66, v67
  v_lshlrev_b32 v60, 16, v216
  v_and_b32 v61, 0xffff0000, v216
  v_lshlrev_b32 v62, 16, v217
  v_and_b32 v63, 0xffff0000, v217
  v_lshlrev_b32 v64, 16, v218
  v_and_b32 v65, 0xffff0000, v218
  v_lshlrev_b32 v66, 16, v219
  v_and_b32 v67, 0xffff0000, v219
  v_pk_mul_f32 v[60:61], v[60:61], v[52:53]
  v_pk_mul_f32 v[62:63], v[62:63], v[54:55]
  v_pk_mul_f32 v[64:65], v[64:65], v[56:57]
  v_pk_mul_f32 v[66:67], v[66:67], v[58:59]
  v_cvt_pk_bf16_f32 v216, v60, v61
  v_cvt_pk_bf16_f32 v217, v62, v63
  v_cvt_pk_bf16_f32 v218, v64, v65
  v_cvt_pk_bf16_f32 v219, v66, v67
  v_cvt_pk_bf16_f32 v72, v62, v63
  v_cvt_pk_bf16_f32 v73, v64, v65
  ds_write_b128 v224, v[216:219] offset:51472
  ds_write_b64 v224, v[216:217] offset:42200
  ds_write_b64 v224, v[218:219] offset:42208
  ds_write_b32 v224, v216 offset:37564
  ds_write_b64 v224, v[72:73] offset:37568
  ds_write_b32 v224, v219 offset:37576
  ds_write_b32 v224, v216 offset:46836
  ds_write_b64 v224, v[72:73] offset:46840
  ds_write_b32 v224, v219 offset:46848
  v_lshlrev_b32 v60, 16, v208
  v_and_b32 v61, 0xffff0000, v208
  v_lshlrev_b32 v62, 16, v209
  v_and_b32 v63, 0xffff0000, v209
  v_lshlrev_b32 v64, 16, v210
  v_and_b32 v65, 0xffff0000, v210
  v_lshlrev_b32 v66, 16, v211
  v_and_b32 v67, 0xffff0000, v211
  s_bitcmp1_b32 s58, 0
  s_cselect_b32 s70, 0, 16
  s_lshl_b32 s34, s34, s70
  s_and_b32 s34, s34, 0xffff0000
  v_mul_f32 v60, s34, v60
  v_mul_f32 v61, s34, v61
  v_mul_f32 v62, s34, v62
  v_mul_f32 v63, s34, v63
  v_mul_f32 v64, s34, v64
  v_mul_f32 v65, s34, v65
  v_mul_f32 v66, s34, v66
  v_mul_f32 v67, s34, v67
  v_cvt_pk_bf16_f32 v76, v60, v61
  v_cvt_pk_bf16_f32 v77, v62, v63
  v_cvt_pk_bf16_f32 v78, v64, v65
  v_cvt_pk_bf16_f32 v79, v66, v67
  v_lshlrev_b32 v226, 16, v76
  v_and_b32 v227, 0xffff0000, v76
  v_lshlrev_b32 v228, 16, v77
  v_and_b32 v229, 0xffff0000, v77
  v_lshlrev_b32 v230, 16, v78
  v_and_b32 v231, 0xffff0000, v78
  v_lshlrev_b32 v232, 16, v79
  v_and_b32 v233, 0xffff0000, v79
  v_lshlrev_b32 v60, 16, v212
  v_and_b32 v61, 0xffff0000, v212
  v_lshlrev_b32 v62, 16, v213
  v_and_b32 v63, 0xffff0000, v213
  v_lshlrev_b32 v64, 16, v214
  v_and_b32 v65, 0xffff0000, v214
  v_lshlrev_b32 v66, 16, v215
  v_and_b32 v67, 0xffff0000, v215
  s_bitcmp1_b32 s59, 0
  s_cselect_b32 s70, 0, 16
  s_lshl_b32 s35, s35, s70
  s_and_b32 s35, s35, 0xffff0000
  v_mul_f32 v60, s35, v60
  v_mul_f32 v61, s35, v61
  v_mul_f32 v62, s35, v62
  v_mul_f32 v63, s35, v63
  v_mul_f32 v64, s35, v64
  v_mul_f32 v65, s35, v65
  v_mul_f32 v66, s35, v66
  v_mul_f32 v67, s35, v67
  v_cvt_pk_bf16_f32 v76, v60, v61
  v_cvt_pk_bf16_f32 v77, v62, v63
  v_cvt_pk_bf16_f32 v78, v64, v65
  v_cvt_pk_bf16_f32 v79, v66, v67
  v_lshlrev_b32 v234, 16, v76
  v_and_b32 v235, 0xffff0000, v76
  v_lshlrev_b32 v236, 16, v77
  v_and_b32 v237, 0xffff0000, v77
  v_lshlrev_b32 v238, 16, v78
  v_and_b32 v239, 0xffff0000, v78
  v_lshlrev_b32 v240, 16, v79
  v_and_b32 v241, 0xffff0000, v79
  v_lshlrev_b32 v60, 16, v216
  v_and_b32 v61, 0xffff0000, v216
  v_lshlrev_b32 v62, 16, v217
  v_and_b32 v63, 0xffff0000, v217
  v_lshlrev_b32 v64, 16, v218
  v_and_b32 v65, 0xffff0000, v218
  v_lshlrev_b32 v66, 16, v219
  v_and_b32 v67, 0xffff0000, v219
  s_bitcmp1_b32 s61, 0
  s_cselect_b32 s70, 0, 16
  s_lshl_b32 s42, s42, s70
  s_and_b32 s42, s42, 0xffff0000
  v_mul_f32 v60, s42, v60
  v_mul_f32 v61, s42, v61
  v_mul_f32 v62, s42, v62
  v_mul_f32 v63, s42, v63
  v_mul_f32 v64, s42, v64
  v_mul_f32 v65, s42, v65
  v_mul_f32 v66, s42, v66
  v_mul_f32 v67, s42, v67
  v_cvt_pk_bf16_f32 v76, v60, v61
  v_cvt_pk_bf16_f32 v77, v62, v63
  v_cvt_pk_bf16_f32 v78, v64, v65
  v_cvt_pk_bf16_f32 v79, v66, v67
  v_lshlrev_b32 v242, 16, v76
  v_and_b32 v243, 0xffff0000, v76
  v_lshlrev_b32 v244, 16, v77
  v_and_b32 v245, 0xffff0000, v77
  v_lshlrev_b32 v246, 16, v78
  v_and_b32 v247, 0xffff0000, v78
  v_lshlrev_b32 v248, 16, v79
  v_and_b32 v249, 0xffff0000, v79
  s_waitcnt lgkmcnt(0)
  s_barrier
  s_lshr_b32 s62, s3, 1
  s_cmp_eq_u32 s3, 1
  s_cbranch_scc1 Lcv_w1
  s_cmp_eq_u32 s3, 3
  s_cbranch_scc1 Lcv_w3
  s_mul_i32 s70, s62, 8448
  s_mul_i32 s71, s62, 18560
  v_add_u32 v16, s70, v14
  v_add_u32 v17, s71, v15
  ds_read_b128 v[44:47], v16 offset:0
  ds_read_b128 v[48:51], v17 offset:0
  ds_read_b128 v[52:55], v16 offset:512
  ds_read_b128 v[56:59], v17 offset:512
  ds_read_b128 v[60:63], v16 offset:1024
  ds_read_b128 v[64:67], v17 offset:1024
  ds_read_b128 v[68:71], v16 offset:1536
  ds_read_b128 v[72:75], v17 offset:1536
  ds_read_b128 v[76:79], v16 offset:2048
  ds_read_b128 v[80:83], v17 offset:2048
  ds_read_b128 v[84:87], v16 offset:2560
  ds_read_b128 v[88:91], v17 offset:2560
  ds_read_b128 v[92:95], v16 offset:3072
  ds_read_b128 v[96:99], v17 offset:3072
  ds_read_b128 v[100:103], v16 offset:3584
  ds_read_b128 v[104:107], v17 offset:3584
  v_add_u32 v16, 64, v16
  v_add_u32 v17, -64, v17
  v_mov_b32 v20, 0
  v_mov_b32 v21, 0
  v_mov_b32 v22, 0
  v_mov_b32 v23, 0
  v_mov_b32 v24, 0
  v_mov_b32 v25, 0
  v_mov_b32 v26, 0
  v_mov_b32 v27, 0
  v_mov_b32 v28, 0
  v_mov_b32 v29, 0
  v_mov_b32 v30, 0
  v_mov_b32 v31, 0
  v_mov_b32 v32, 0
  v_mov_b32 v33, 0
  v_mov_b32 v34, 0
  v_mov_b32 v35, 0
  s_mov_b32 s64, 4
Lcv_l0:
  s_waitcnt lgkmcnt(0)
  v_mfma_f32_16x16x32_bf16 v[20:23], v[44:47], v[104:107], v[20:23]
  ds_read_b128 v[132:135], v16 offset:0
  v_mfma_f32_16x16x32_bf16 v[24:27], v[44:47], v[96:99], v[24:27]
  ds_read_b128 v[136:139], v17 offset:0
  v_mfma_f32_16x16x32_bf16 v[28:31], v[44:47], v[88:91], v[28:31]
  ds_read_b128 v[140:143], v16 offset:512
  v_mfma_f32_16x16x32_bf16 v[20:23], v[52:55], v[96:99], v[20:23]
  ds_read_b128 v[144:147], v17 offset:512
  v_mfma_f32_16x16x32_bf16 v[24:27], v[52:55], v[88:91], v[24:27]
  ds_read_b128 v[148:151], v16 offset:1024
  v_mfma_f32_16x16x32_bf16 v[28:31], v[52:55], v[80:83], v[28:31]
  ds_read_b128 v[152:155], v17 offset:1024
  v_mfma_f32_16x16x32_bf16 v[20:23], v[60:63], v[88:91], v[20:23]
  ds_read_b128 v[156:159], v16 offset:1536
  v_mfma_f32_16x16x32_bf16 v[24:27], v[60:63], v[80:83], v[24:27]
  ds_read_b128 v[160:163], v17 offset:1536
  v_mfma_f32_16x16x32_bf16 v[28:31], v[60:63], v[72:75], v[28:31]
  ds_read_b128 v[164:167], v16 offset:2048
  v_mfma_f32_16x16x32_bf16 v[20:23], v[68:71], v[80:83], v[20:23]
  ds_read_b128 v[168:171], v17 offset:2048
  v_mfma_f32_16x16x32_bf16 v[24:27], v[68:71], v[72:75], v[24:27]
  ds_read_b128 v[172:175], v16 offset:2560
  v_mfma_f32_16x16x32_bf16 v[28:31], v[68:71], v[64:67], v[28:31]
  ds_read_b128 v[176:179], v17 offset:2560
  v_mfma_f32_16x16x32_bf16 v[20:23], v[76:79], v[72:75], v[20:23]
  ds_read_b128 v[180:183], v16 offset:3072
  v_mfma_f32_16x16x32_bf16 v[24:27], v[76:79], v[64:67], v[24:27]
  ds_read_b128 v[184:187], v17 offset:3072
  v_mfma_f32_16x16x32_bf16 v[28:31], v[76:79], v[56:59], v[28:31]
  ds_read_b128 v[188:191], v16 offset:3584
  v_mfma_f32_16x16x32_bf16 v[20:23], v[84:87], v[64:67], v[20:23]
  ds_read_b128 v[192:195], v17 offset:3584
  v_mfma_f32_16x16x32_bf16 v[24:27], v[84:87], v[56:59], v[24:27]
  v_add_u32 v16, 64, v16
  v_mfma_f32_16x16x32_bf16 v[32:35], v[44:47], v[56:59], v[32:35]
  v_add_u32 v17, -64, v17
  v_mfma_f32_16x16x32_bf16 v[20:23], v[92:95], v[56:59], v[20:23]
  v_mfma_f32_16x16x32_bf16 v[24:27], v[92:95], v[48:51], v[24:27]
  v_mfma_f32_16x16x32_bf16 v[28:31], v[84:87], v[48:51], v[28:31]
  v_mfma_f32_16x16x32_bf16 v[20:23], v[100:103], v[48:51], v[20:23]
  v_mfma_f32_16x16x32_bf16 v[32:35], v[52:55], v[48:51], v[32:35]
  s_waitcnt lgkmcnt(0)
  v_mfma_f32_16x16x32_bf16 v[20:23], v[132:135], v[192:195], v[20:23]
  ds_read_b128 v[44:47], v16 offset:0
  v_mfma_f32_16x16x32_bf16 v[24:27], v[132:135], v[184:187], v[24:27]
  ds_read_b128 v[48:51], v17 offset:0
  v_mfma_f32_16x16x32_bf16 v[28:31], v[132:135], v[176:179], v[28:31]
  ds_read_b128 v[52:55], v16 offset:512
  v_mfma_f32_16x16x32_bf16 v[20:23], v[140:143], v[184:187], v[20:23]
  ds_read_b128 v[56:59], v17 offset:512
  v_mfma_f32_16x16x32_bf16 v[24:27], v[140:143], v[176:179], v[24:27]
  ds_read_b128 v[60:63], v16 offset:1024
  v_mfma_f32_16x16x32_bf16 v[28:31], v[140:143], v[168:171], v[28:31]
  ds_read_b128 v[64:67], v17 offset:1024
  v_mfma_f32_16x16x32_bf16 v[20:23], v[148:151], v[176:179], v[20:23]
  ds_read_b128 v[68:71], v16 offset:1536
  v_mfma_f32_16x16x32_bf16 v[24:27], v[148:151], v[168:171], v[24:27]
  ds_read_b128 v[72:75], v17 offset:1536
  v_mfma_f32_16x16x32_bf16 v[28:31], v[148:151], v[160:163], v[28:31]
  ds_read_b128 v[76:79], v16 offset:2048
  v_mfma_f32_16x16x32_bf16 v[20:23], v[156:159], v[168:171], v[20:23]
  ds_read_b128 v[80:83], v17 offset:2048
  v_mfma_f32_16x16x32_bf16 v[24:27], v[156:159], v[160:163], v[24:27]
  ds_read_b128 v[84:87], v16 offset:2560
  v_mfma_f32_16x16x32_bf16 v[28:31], v[156:159], v[152:155], v[28:31]
  ds_read_b128 v[88:91], v17 offset:2560
  v_mfma_f32_16x16x32_bf16 v[20:23], v[164:167], v[160:163], v[20:23]
  ds_read_b128 v[92:95], v16 offset:3072
  v_mfma_f32_16x16x32_bf16 v[24:27], v[164:167], v[152:155], v[24:27]
  ds_read_b128 v[96:99], v17 offset:3072
  v_mfma_f32_16x16x32_bf16 v[28:31], v[164:167], v[144:147], v[28:31]
  ds_read_b128 v[100:103], v16 offset:3584
  v_mfma_f32_16x16x32_bf16 v[20:23], v[172:175], v[152:155], v[20:23]
  ds_read_b128 v[104:107], v17 offset:3584
  v_mfma_f32_16x16x32_bf16 v[24:27], v[172:175], v[144:147], v[24:27]
  v_add_u32 v16, 64, v16
  v_mfma_f32_16x16x32_bf16 v[32:35], v[132:135], v[144:147], v[32:35]
  v_add_u32 v17, -64, v17
  v_mfma_f32_16x16x32_bf16 v[20:23], v[180:183], v[144:147], v[20:23]
  v_mfma_f32_16x16x32_bf16 v[24:27], v[180:183], v[136:139], v[24:27]
  v_mfma_f32_16x16x32_bf16 v[28:31], v[172:175], v[136:139], v[28:31]
  v_mfma_f32_16x16x32_bf16 v[20:23], v[188:191], v[136:139], v[20:23]
  v_mfma_f32_16x16x32_bf16 v[32:35], v[140:143], v[136:139], v[32:35]
  s_sub_u32 s64, s64, 1
  s_cmp_lg_u32 s64, 0
  s_cbranch_scc1 Lcv_l0
  s_waitcnt lgkmcnt(0)
  s_barrier
  s_lshl_b32 s70, s62, 12
  v_add_u32 v16, s70, v19
  v_cvt_pk_bf16_f32 v20, v20, v21
  v_cvt_pk_bf16_f32 v22, v22, v23
  ds_write_b32 v16, v20 offset:3584
  ds_write_b32 v16, v22 offset:3600
  v_cvt_pk_bf16_f32 v24, v24, v25
  v_cvt_pk_bf16_f32 v26, v26, v27
  ds_write_b32 v16, v24 offset:3072
  ds_write_b32 v16, v26 offset:3088
  v_cvt_pk_bf16_f32 v28, v28, v29
  v_cvt_pk_bf16_f32 v30, v30, v31
  ds_write_b32 v16, v28 offset:2560
  ds_write_b32 v16, v30 offset:2576
  v_cvt_pk_bf16_f32 v32, v32, v33
  v_cvt_pk_bf16_f32 v34, v34, v35
  ds_write_b32 v16, v32 offset:512
  ds_write_b32 v16, v34 offset:528
  s_branch Lcv_bar2
Lcv_w1:
  v_add_u32 v16, 0, v14
  v_add_u32 v17, 0, v15
  v_add_u32 v8, 8448, v14
  v_add_u32 v9, 18560, v15
  ds_read_b128 v[44:47], v16 offset:0
  ds_read_b128 v[48:51], v17 offset:0
  ds_read_b128 v[52:55], v16 offset:512
  ds_read_b128 v[56:59], v17 offset:512
  ds_read_b128 v[60:63], v16 offset:1024
  ds_read_b128 v[64:67], v17 offset:1024
  ds_read_b128 v[68:71], v16 offset:1536
  ds_read_b128 v[72:75], v17 offset:1536
  ds_read_b128 v[76:79], v16 offset:2048
  ds_read_b128 v[80:83], v17 offset:2048
  v_add_u32 v16, 64, v16
  v_add_u32 v17, -64, v17
  ds_read_b128 v[84:87], v8 offset:0
  ds_read_b128 v[88:91], v9 offset:0
  ds_read_b128 v[92:95], v8 offset:512
  ds_read_b128 v[96:99], v9 offset:512
  ds_read_b128 v[100:103], v8 offset:1024
  ds_read_b128 v[104:107], v9 offset:1024
  ds_read_b128 v[108:111], v8 offset:1536
  ds_read_b128 v[112:115], v9 offset:1536
  ds_read_b128 v[116:119], v8 offset:2048
  ds_read_b128 v[120:123], v9 offset:2048
  v_add_u32 v8, 64, v8
  v_add_u32 v9, -64, v9
  v_mov_b32 v20, 0
  v_mov_b32 v21, 0
  v_mov_b32 v22, 0
  v_mov_b32 v23, 0
  v_mov_b32 v24, 0
  v_mov_b32 v25, 0
  v_mov_b32 v26, 0
  v_mov_b32 v27, 0
  v_mov_b32 v28, 0
  v_mov_b32 v29, 0
  v_mov_b32 v30, 0
  v_mov_b32 v31, 0
  v_mov_b32 v32, 0
  v_mov_b32 v33, 0
  v_mov_b32 v34, 0
  v_mov_b32 v35, 0
  v_mov_b32 v36, 0
  v_mov_b32 v37, 0
  v_mov_b32 v38, 0
  v_mov_b32 v39, 0
  v_mov_b32 v40, 0
  v_mov_b32 v41, 0
  v_mov_b32 v42, 0
  v_mov_b32 v43, 0
  s_mov_b32 s64, 4
Lcv_l1:
  s_waitcnt lgkmcnt(0)
  v_mfma_f32_16x16x32_bf16 v[20:23], v[44:47], v[80:83], v[20:23]
  ds_read_b128 v[132:135], v16 offset:0
  ds_read_b128 v[136:139], v17 offset:0
  v_mfma_f32_16x16x32_bf16 v[36:39], v[84:87], v[120:123], v[36:39]
  ds_read_b128 v[140:143], v16 offset:512
  v_mfma_f32_16x16x32_bf16 v[24:27], v[44:47], v[72:75], v[24:27]
  ds_read_b128 v[144:147], v17 offset:512
  v_mfma_f32_16x16x32_bf16 v[20:23], v[52:55], v[72:75], v[20:23]
  ds_read_b128 v[148:151], v16 offset:1024
  ds_read_b128 v[152:155], v17 offset:1024
  v_mfma_f32_16x16x32_bf16 v[36:39], v[92:95], v[112:115], v[36:39]
  ds_read_b128 v[156:159], v16 offset:1536
  v_mfma_f32_16x16x32_bf16 v[40:43], v[84:87], v[112:115], v[40:43]
  ds_read_b128 v[160:163], v17 offset:1536
  v_mfma_f32_16x16x32_bf16 v[20:23], v[60:63], v[64:67], v[20:23]
  ds_read_b128 v[164:167], v16 offset:2048
  ds_read_b128 v[168:171], v17 offset:2048
  v_mfma_f32_16x16x32_bf16 v[24:27], v[52:55], v[64:67], v[24:27]
  v_add_u32 v16, 64, v16
  v_mfma_f32_16x16x32_bf16 v[28:31], v[44:47], v[64:67], v[28:31]
  v_add_u32 v17, -64, v17
  v_mfma_f32_16x16x32_bf16 v[36:39], v[100:103], v[104:107], v[36:39]
  ds_read_b128 v[172:175], v8 offset:0
  ds_read_b128 v[176:179], v9 offset:0
  v_mfma_f32_16x16x32_bf16 v[40:43], v[92:95], v[104:107], v[40:43]
  ds_read_b128 v[180:183], v8 offset:512
  v_mfma_f32_16x16x32_bf16 v[20:23], v[68:71], v[56:59], v[20:23]
  ds_read_b128 v[184:187], v9 offset:512
  v_mfma_f32_16x16x32_bf16 v[24:27], v[60:63], v[56:59], v[24:27]
  ds_read_b128 v[188:191], v8 offset:1024
  ds_read_b128 v[192:195], v9 offset:1024
  v_mfma_f32_16x16x32_bf16 v[28:31], v[52:55], v[56:59], v[28:31]
  ds_read_b128 v[196:199], v8 offset:1536
  v_mfma_f32_16x16x32_bf16 v[36:39], v[108:111], v[96:99], v[36:39]
  ds_read_b128 v[200:203], v9 offset:1536
  v_mfma_f32_16x16x32_bf16 v[40:43], v[100:103], v[96:99], v[40:43]
  ds_read_b128 v[204:207], v8 offset:2048
  ds_read_b128 v[208:211], v9 offset:2048
  v_mfma_f32_16x16x32_bf16 v[20:23], v[76:79], v[48:51], v[20:23]
  v_add_u32 v8, 64, v8
  v_mfma_f32_16x16x32_bf16 v[24:27], v[68:71], v[48:51], v[24:27]
  v_add_u32 v9, -64, v9
  v_mfma_f32_16x16x32_bf16 v[28:31], v[60:63], v[48:51], v[28:31]
  v_mfma_f32_16x16x32_bf16 v[32:35], v[44:47], v[48:51], v[32:35]
  v_mfma_f32_16x16x32_bf16 v[36:39], v[116:119], v[88:91], v[36:39]
  v_mfma_f32_16x16x32_bf16 v[40:43], v[108:111], v[88:91], v[40:43]
  s_waitcnt lgkmcnt(0)
  v_mfma_f32_16x16x32_bf16 v[20:23], v[132:135], v[168:171], v[20:23]
  ds_read_b128 v[44:47], v16 offset:0
  ds_read_b128 v[48:51], v17 offset:0
  v_mfma_f32_16x16x32_bf16 v[36:39], v[172:175], v[208:211], v[36:39]
  ds_read_b128 v[52:55], v16 offset:512
  v_mfma_f32_16x16x32_bf16 v[24:27], v[132:135], v[160:163], v[24:27]
  ds_read_b128 v[56:59], v17 offset:512
  v_mfma_f32_16x16x32_bf16 v[20:23], v[140:143], v[160:163], v[20:23]
  ds_read_b128 v[60:63], v16 offset:1024
  ds_read_b128 v[64:67], v17 offset:1024
  v_mfma_f32_16x16x32_bf16 v[36:39], v[180:183], v[200:203], v[36:39]
  ds_read_b128 v[68:71], v16 offset:1536
  v_mfma_f32_16x16x32_bf16 v[40:43], v[172:175], v[200:203], v[40:43]
  ds_read_b128 v[72:75], v17 offset:1536
  v_mfma_f32_16x16x32_bf16 v[20:23], v[148:151], v[152:155], v[20:23]
  ds_read_b128 v[76:79], v16 offset:2048
  ds_read_b128 v[80:83], v17 offset:2048
  v_mfma_f32_16x16x32_bf16 v[24:27], v[140:143], v[152:155], v[24:27]
  v_add_u32 v16, 64, v16
  v_mfma_f32_16x16x32_bf16 v[28:31], v[132:135], v[152:155], v[28:31]
  v_add_u32 v17, -64, v17
  v_mfma_f32_16x16x32_bf16 v[36:39], v[188:191], v[192:195], v[36:39]
  ds_read_b128 v[84:87], v8 offset:0
  ds_read_b128 v[88:91], v9 offset:0
  v_mfma_f32_16x16x32_bf16 v[40:43], v[180:183], v[192:195], v[40:43]
  ds_read_b128 v[92:95], v8 offset:512
  v_mfma_f32_16x16x32_bf16 v[20:23], v[156:159], v[144:147], v[20:23]
  ds_read_b128 v[96:99], v9 offset:512
  v_mfma_f32_16x16x32_bf16 v[24:27], v[148:151], v[144:147], v[24:27]
  ds_read_b128 v[100:103], v8 offset:1024
  ds_read_b128 v[104:107], v9 offset:1024
  v_mfma_f32_16x16x32_bf16 v[28:31], v[140:143], v[144:147], v[28:31]
  ds_read_b128 v[108:111], v8 offset:1536
  v_mfma_f32_16x16x32_bf16 v[36:39], v[196:199], v[184:187], v[36:39]
  ds_read_b128 v[112:115], v9 offset:1536
  v_mfma_f32_16x16x32_bf16 v[40:43], v[188:191], v[184:187], v[40:43]
  ds_read_b128 v[116:119], v8 offset:2048
  ds_read_b128 v[120:123], v9 offset:2048
  v_mfma_f32_16x16x32_bf16 v[20:23], v[164:167], v[136:139], v[20:23]
  v_add_u32 v8, 64, v8
  v_mfma_f32_16x16x32_bf16 v[24:27], v[156:159], v[136:139], v[24:27]
  v_add_u32 v9, -64, v9
  v_mfma_f32_16x16x32_bf16 v[28:31], v[148:151], v[136:139], v[28:31]
  v_mfma_f32_16x16x32_bf16 v[32:35], v[132:135], v[136:139], v[32:35]
  v_mfma_f32_16x16x32_bf16 v[36:39], v[204:207], v[176:179], v[36:39]
  v_mfma_f32_16x16x32_bf16 v[40:43], v[196:199], v[176:179], v[40:43]
  s_sub_u32 s64, s64, 1
  s_cmp_lg_u32 s64, 0
  s_cbranch_scc1 Lcv_l1
  s_waitcnt lgkmcnt(0)
  s_barrier
  v_cvt_pk_bf16_f32 v20, v20, v21
  v_cvt_pk_bf16_f32 v22, v22, v23
  ds_write_b32 v19, v20 offset:2048
  ds_write_b32 v19, v22 offset:2064
  v_cvt_pk_bf16_f32 v24, v24, v25
  v_cvt_pk_bf16_f32 v26, v26, v27
  ds_write_b32 v19, v24 offset:1536
  ds_write_b32 v19, v26 offset:1552
  v_cvt_pk_bf16_f32 v28, v28, v29
  v_cvt_pk_bf16_f32 v30, v30, v31
  ds_write_b32 v19, v28 offset:1024
  ds_write_b32 v19, v30 offset:1040
  v_cvt_pk_bf16_f32 v32, v32, v33
  v_cvt_pk_bf16_f32 v34, v34, v35
  ds_write_b32 v19, v32 offset:0
  ds_write_b32 v19, v34 offset:16
  v_cvt_pk_bf16_f32 v36, v36, v37
  v_cvt_pk_bf16_f32 v38, v38, v39
  ds_write_b32 v19, v36 offset:6144
  ds_write_b32 v19, v38 offset:6160
  v_cvt_pk_bf16_f32 v40, v40, v41
  v_cvt_pk_bf16_f32 v42, v42, v43
  ds_write_b32 v19, v40 offset:5632
  ds_write_b32 v19, v42 offset:5648
  s_branch Lcv_bar2
Lcv_w3:
  s_cmp_eq_u32 s57, 1
  s_cbranch_scc1 Lcv_w3b
  v_add_u32 v16, 8448, v14
  v_add_u32 v17, 18560, v15
  v_add_u32 v8, 16896, v14
  v_add_u32 v9, 37120, v15
  ds_read_b128 v[44:47], v16 offset:0
  ds_read_b128 v[48:51], v17 offset:0
  ds_read_b128 v[52:55], v16 offset:512
  ds_read_b128 v[56:59], v17 offset:512
  ds_read_b128 v[60:63], v16 offset:1024
  ds_read_b128 v[64:67], v17 offset:1024
  v_add_u32 v16, 64, v16
  v_add_u32 v17, -64, v17
  ds_read_b128 v[68:71], v8 offset:0
  ds_read_b128 v[72:75], v9 offset:0
  ds_read_b128 v[76:79], v8 offset:512
  ds_read_b128 v[80:83], v9 offset:512
  ds_read_b128 v[84:87], v8 offset:1024
  ds_read_b128 v[88:91], v9 offset:1024
  ds_read_b128 v[92:95], v8 offset:1536
  ds_read_b128 v[96:99], v9 offset:1536
  ds_read_b128 v[100:103], v8 offset:2048
  ds_read_b128 v[104:107], v9 offset:2048
  ds_read_b128 v[108:111], v8 offset:2560
  ds_read_b128 v[112:115], v9 offset:2560
  ds_read_b128 v[116:119], v8 offset:3072
  ds_read_b128 v[120:123], v9 offset:3072
  ds_read_b128 v[124:127], v8 offset:3584
  ds_read_b128 v[128:131], v9 offset:3584
  v_add_u32 v8, 64, v8
  v_add_u32 v9, -64, v9
  v_mov_b32 v20, 0
  v_mov_b32 v21, 0
  v_mov_b32 v22, 0
  v_mov_b32 v23, 0
  v_mov_b32 v24, 0
  v_mov_b32 v25, 0
  v_mov_b32 v26, 0
  v_mov_b32 v27, 0
  v_mov_b32 v28, 0
  v_mov_b32 v29, 0
  v_mov_b32 v30, 0
  v_mov_b32 v31, 0
  v_mov_b32 v32, 0
  v_mov_b32 v33, 0
  v_mov_b32 v34, 0
  v_mov_b32 v35, 0
  v_mov_b32 v36, 0
  v_mov_b32 v37, 0
  v_mov_b32 v38, 0
  v_mov_b32 v39, 0
  v_mov_b32 v40, 0
  v_mov_b32 v41, 0
  v_mov_b32 v42, 0
  v_mov_b32 v43, 0
  s_mov_b32 s64, 4
Lcv_l3a:
  s_waitcnt lgkmcnt(0)
  v_mfma_f32_16x16x32_bf16 v[28:31], v[68:71], v[128:131], v[28:31]
  ds_read_b128 v[132:135], v16 offset:0
  ds_read_b128 v[136:139], v17 offset:0
  v_mfma_f32_16x16x32_bf16 v[32:35], v[68:71], v[112:115], v[32:35]
  ds_read_b128 v[140:143], v16 offset:512
  v_mfma_f32_16x16x32_bf16 v[20:23], v[44:47], v[64:67], v[20:23]
  ds_read_b128 v[144:147], v17 offset:512
  ds_read_b128 v[148:151], v16 offset:1024
  v_mfma_f32_16x16x32_bf16 v[28:31], v[76:79], v[120:123], v[28:31]
  ds_read_b128 v[152:155], v17 offset:1024
  v_mfma_f32_16x16x32_bf16 v[32:35], v[76:79], v[104:107], v[32:35]
  v_add_u32 v16, 64, v16
  v_add_u32 v17, -64, v17
  v_mfma_f32_16x16x32_bf16 v[36:39], v[68:71], v[88:91], v[36:39]
  ds_read_b128 v[156:159], v8 offset:0
  v_mfma_f32_16x16x32_bf16 v[28:31], v[84:87], v[112:115], v[28:31]
  ds_read_b128 v[160:163], v9 offset:0
  ds_read_b128 v[164:167], v8 offset:512
  v_mfma_f32_16x16x32_bf16 v[32:35], v[84:87], v[96:99], v[32:35]
  ds_read_b128 v[168:171], v9 offset:512
  v_mfma_f32_16x16x32_bf16 v[20:23], v[52:55], v[56:59], v[20:23]
  ds_read_b128 v[172:175], v8 offset:1024
  v_mfma_f32_16x16x32_bf16 v[28:31], v[92:95], v[104:107], v[28:31]
  ds_read_b128 v[176:179], v9 offset:1024
  ds_read_b128 v[180:183], v8 offset:1536
  v_mfma_f32_16x16x32_bf16 v[32:35], v[92:95], v[88:91], v[32:35]
  ds_read_b128 v[184:187], v9 offset:1536
  v_mfma_f32_16x16x32_bf16 v[36:39], v[76:79], v[80:83], v[36:39]
  ds_read_b128 v[188:191], v8 offset:2048
  ds_read_b128 v[192:195], v9 offset:2048
  v_mfma_f32_16x16x32_bf16 v[28:31], v[100:103], v[96:99], v[28:31]
  ds_read_b128 v[196:199], v8 offset:2560
  v_mfma_f32_16x16x32_bf16 v[32:35], v[100:103], v[80:83], v[32:35]
  ds_read_b128 v[200:203], v9 offset:2560
  ds_read_b128 v[204:207], v8 offset:3072
  v_mfma_f32_16x16x32_bf16 v[20:23], v[60:63], v[48:51], v[20:23]
  ds_read_b128 v[208:211], v9 offset:3072
  v_mfma_f32_16x16x32_bf16 v[28:31], v[108:111], v[88:91], v[28:31]
  ds_read_b128 v[212:215], v8 offset:3584
  ds_read_b128 v[216:219], v9 offset:3584
  v_mfma_f32_16x16x32_bf16 v[24:27], v[44:47], v[48:51], v[24:27]
  v_add_u32 v8, 64, v8
  v_mfma_f32_16x16x32_bf16 v[32:35], v[108:111], v[72:75], v[32:35]
  v_add_u32 v9, -64, v9
  v_mfma_f32_16x16x32_bf16 v[28:31], v[116:119], v[80:83], v[28:31]
  v_mfma_f32_16x16x32_bf16 v[36:39], v[84:87], v[72:75], v[36:39]
  v_mfma_f32_16x16x32_bf16 v[40:43], v[68:71], v[72:75], v[40:43]
  v_mfma_f32_16x16x32_bf16 v[28:31], v[124:127], v[72:75], v[28:31]
  s_waitcnt lgkmcnt(0)
  v_mfma_f32_16x16x32_bf16 v[28:31], v[156:159], v[216:219], v[28:31]
  ds_read_b128 v[44:47], v16 offset:0
  ds_read_b128 v[48:51], v17 offset:0
  v_mfma_f32_16x16x32_bf16 v[32:35], v[156:159], v[200:203], v[32:35]
  ds_read_b128 v[52:55], v16 offset:512
  v_mfma_f32_16x16x32_bf16 v[20:23], v[132:135], v[152:155], v[20:23]
  ds_read_b128 v[56:59], v17 offset:512
  ds_read_b128 v[60:63], v16 offset:1024
  v_mfma_f32_16x16x32_bf16 v[28:31], v[164:167], v[208:211], v[28:31]
  ds_read_b128 v[64:67], v17 offset:1024
  v_mfma_f32_16x16x32_bf16 v[32:35], v[164:167], v[192:195], v[32:35]
  v_add_u32 v16, 64, v16
  v_add_u32 v17, -64, v17
  v_mfma_f32_16x16x32_bf16 v[36:39], v[156:159], v[176:179], v[36:39]
  ds_read_b128 v[68:71], v8 offset:0
  v_mfma_f32_16x16x32_bf16 v[28:31], v[172:175], v[200:203], v[28:31]
  ds_read_b128 v[72:75], v9 offset:0
  ds_read_b128 v[76:79], v8 offset:512
  v_mfma_f32_16x16x32_bf16 v[32:35], v[172:175], v[184:187], v[32:35]
  ds_read_b128 v[80:83], v9 offset:512
  v_mfma_f32_16x16x32_bf16 v[20:23], v[140:143], v[144:147], v[20:23]
  ds_read_b128 v[84:87], v8 offset:1024
  v_mfma_f32_16x16x32_bf16 v[28:31], v[180:183], v[192:195], v[28:31]
  ds_read_b128 v[88:91], v9 offset:1024
  ds_read_b128 v[92:95], v8 offset:1536
  v_mfma_f32_16x16x32_bf16 v[32:35], v[180:183], v[176:179], v[32:35]
  ds_read_b128 v[96:99], v9 offset:1536
  v_mfma_f32_16x16x32_bf16 v[36:39], v[164:167], v[168:171], v[36:39]
  ds_read_b128 v[100:103], v8 offset:2048
  ds_read_b128 v[104:107], v9 offset:2048
  v_mfma_f32_16x16x32_bf16 v[28:31], v[188:191], v[184:187], v[28:31]
  ds_read_b128 v[108:111], v8 offset:2560
  v_mfma_f32_16x16x32_bf16 v[32:35], v[188:191], v[168:171], v[32:35]
  ds_read_b128 v[112:115], v9 offset:2560
  ds_read_b128 v[116:119], v8 offset:3072
  v_mfma_f32_16x16x32_bf16 v[20:23], v[148:151], v[136:139], v[20:23]
  ds_read_b128 v[120:123], v9 offset:3072
  v_mfma_f32_16x16x32_bf16 v[28:31], v[196:199], v[176:179], v[28:31]
  ds_read_b128 v[124:127], v8 offset:3584
  ds_read_b128 v[128:131], v9 offset:3584
  v_mfma_f32_16x16x32_bf16 v[24:27], v[132:135], v[136:139], v[24:27]
  v_add_u32 v8, 64, v8
  v_mfma_f32_16x16x32_bf16 v[32:35], v[196:199], v[160:163], v[32:35]
  v_add_u32 v9, -64, v9
  v_mfma_f32_16x16x32_bf16 v[28:31], v[204:207], v[168:171], v[28:31]
  v_mfma_f32_16x16x32_bf16 v[36:39], v[172:175], v[160:163], v[36:39]
  v_mfma_f32_16x16x32_bf16 v[40:43], v[156:159], v[160:163], v[40:43]
  v_mfma_f32_16x16x32_bf16 v[28:31], v[212:215], v[160:163], v[28:31]
  s_sub_u32 s64, s64, 1
  s_cmp_lg_u32 s64, 0
  s_cbranch_scc1 Lcv_l3a
  s_waitcnt lgkmcnt(0)
  s_barrier
  v_cvt_pk_bf16_f32 v20, v20, v21
  v_cvt_pk_bf16_f32 v22, v22, v23
  ds_write_b32 v19, v20 offset:5120
  ds_write_b32 v19, v22 offset:5136
  v_cvt_pk_bf16_f32 v24, v24, v25
  v_cvt_pk_bf16_f32 v26, v26, v27
  ds_write_b32 v19, v24 offset:4096
  ds_write_b32 v19, v26 offset:4112
  v_cvt_pk_bf16_f32 v28, v28, v29
  v_cvt_pk_bf16_f32 v30, v30, v31
  ds_write_b32 v19, v28 offset:11776
  ds_write_b32 v19, v30 offset:11792
  v_cvt_pk_bf16_f32 v32, v32, v33
  v_cvt_pk_bf16_f32 v34, v34, v35
  ds_write_b32 v19, v32 offset:10752
  ds_write_b32 v19, v34 offset:10768
  v_cvt_pk_bf16_f32 v36, v36, v37
  v_cvt_pk_bf16_f32 v38, v38, v39
  ds_write_b32 v19, v36 offset:9216
  ds_write_b32 v19, v38 offset:9232
  v_cvt_pk_bf16_f32 v40, v40, v41
  v_cvt_pk_bf16_f32 v42, v42, v43
  ds_write_b32 v19, v40 offset:8192
  ds_write_b32 v19, v42 offset:8208
  s_branch Lcv_bar2
Lcv_w3b:
  v_add_u32 v16, 8448, v14
  v_add_u32 v17, 18560, v15
  v_add_u32 v8, 16896, v14
  v_add_u32 v9, 37120, v15
  ds_read_b128 v[44:47], v16 offset:0
  ds_read_b128 v[48:51], v17 offset:0
  ds_read_b128 v[52:55], v16 offset:512
  ds_read_b128 v[56:59], v17 offset:512
  ds_read_b128 v[60:63], v16 offset:1024
  ds_read_b128 v[64:67], v17 offset:1024
  v_add_u32 v16, 64, v16
  v_add_u32 v17, -64, v17
  ds_read_b128 v[68:71], v8 offset:0
  ds_read_b128 v[72:75], v9 offset:0
  ds_read_b128 v[76:79], v8 offset:512
  ds_read_b128 v[80:83], v9 offset:512
  ds_read_b128 v[84:87], v8 offset:1024
  ds_read_b128 v[88:91], v9 offset:1024
  ds_read_b128 v[92:95], v8 offset:1536
  ds_read_b128 v[96:99], v9 offset:1536
  ds_read_b128 v[100:103], v8 offset:2048
  ds_read_b128 v[104:107], v9 offset:2048
  ds_read_b128 v[108:111], v8 offset:2560
  ds_read_b128 v[112:115], v9 offset:2560
  ds_read_b128 v[116:119], v8 offset:3072
  ds_read_b128 v[120:123], v9 offset:3072
  v_add_u32 v8, 64, v8
  v_add_u32 v9, -64, v9
  v_mov_b32 v20, 0
  v_mov_b32 v21, 0
  v_mov_b32 v22, 0
  v_mov_b32 v23, 0
  v_mov_b32 v24, 0
  v_mov_b32 v25, 0
  v_mov_b32 v26, 0
  v_mov_b32 v27, 0
  v_mov_b32 v28, 0
  v_mov_b32 v29, 0
  v_mov_b32 v30, 0
  v_mov_b32 v31, 0
  v_mov_b32 v32, 0
  v_mov_b32 v33, 0
  v_mov_b32 v34, 0
  v_mov_b32 v35, 0
  v_mov_b32 v36, 0
  v_mov_b32 v37, 0
  v_mov_b32 v38, 0
  v_mov_b32 v39, 0
  v_mov_b32 v40, 0
  v_mov_b32 v41, 0
  v_mov_b32 v42, 0
  v_mov_b32 v43, 0
  s_mov_b32 s64, 4
Lcv_l3b:
  s_waitcnt lgkmcnt(0)
  v_mfma_f32_16x16x32_bf16 v[28:31], v[68:71], v[120:123], v[28:31]
  ds_read_b128 v[132:135], v16 offset:0
  ds_read_b128 v[136:139], v17 offset:0
  v_mfma_f32_16x16x32_bf16 v[32:35], v[68:71], v[104:107], v[32:35]
  ds_read_b128 v[140:143], v16 offset:512
  v_mfma_f32_16x16x32_bf16 v[36:39], v[68:71], v[96:99], v[36:39]
  ds_read_b128 v[144:147], v17 offset:512
  v_mfma_f32_16x16x32_bf16 v[28:31], v[76:79], v[112:115], v[28:31]
  ds_read_b128 v[148:151], v16 offset:1024
  ds_read_b128 v[152:155], v17 offset:1024
  v_mfma_f32_16x16x32_bf16 v[32:35], v[76:79], v[96:99], v[32:35]
  v_add_u32 v16, 64, v16
  v_mfma_f32_16x16x32_bf16 v[20:23], v[44:47], v[64:67], v[20:23]
  v_add_u32 v17, -64, v17
  v_mfma_f32_16x16x32_bf16 v[28:31], v[84:87], v[104:107], v[28:31]
  ds_read_b128 v[156:159], v8 offset:0
  ds_read_b128 v[160:163], v9 offset:0
  v_mfma_f32_16x16x32_bf16 v[32:35], v[84:87], v[88:91], v[32:35]
  ds_read_b128 v[164:167], v8 offset:512
  v_mfma_f32_16x16x32_bf16 v[36:39], v[76:79], v[88:91], v[36:39]
  ds_read_b128 v[168:171], v9 offset:512
  v_mfma_f32_16x16x32_bf16 v[28:31], v[92:95], v[96:99], v[28:31]
  ds_read_b128 v[172:175], v8 offset:1024
  ds_read_b128 v[176:179], v9 offset:1024
  v_mfma_f32_16x16x32_bf16 v[20:23], v[52:55], v[56:59], v[20:23]
  ds_read_b128 v[180:183], v8 offset:1536
  v_mfma_f32_16x16x32_bf16 v[32:35], v[92:95], v[80:83], v[32:35]
  ds_read_b128 v[184:187], v9 offset:1536
  v_mfma_f32_16x16x32_bf16 v[28:31], v[100:103], v[88:91], v[28:31]
  ds_read_b128 v[188:191], v8 offset:2048
  ds_read_b128 v[192:195], v9 offset:2048
  v_mfma_f32_16x16x32_bf16 v[36:39], v[84:87], v[80:83], v[36:39]
  ds_read_b128 v[196:199], v8 offset:2560
  v_mfma_f32_16x16x32_bf16 v[40:43], v[68:71], v[80:83], v[40:43]
  ds_read_b128 v[200:203], v9 offset:2560
  v_mfma_f32_16x16x32_bf16 v[28:31], v[108:111], v[80:83], v[28:31]
  ds_read_b128 v[204:207], v8 offset:3072
  ds_read_b128 v[208:211], v9 offset:3072
  v_mfma_f32_16x16x32_bf16 v[20:23], v[60:63], v[48:51], v[20:23]
  v_add_u32 v8, 64, v8
  v_mfma_f32_16x16x32_bf16 v[24:27], v[44:47], v[48:51], v[24:27]
  v_add_u32 v9, -64, v9
  v_mfma_f32_16x16x32_bf16 v[28:31], v[116:119], v[72:75], v[28:31]
  v_mfma_f32_16x16x32_bf16 v[32:35], v[100:103], v[72:75], v[32:35]
  v_mfma_f32_16x16x32_bf16 v[36:39], v[92:95], v[72:75], v[36:39]
  v_mfma_f32_16x16x32_bf16 v[40:43], v[76:79], v[72:75], v[40:43]
  s_waitcnt lgkmcnt(0)
  v_mfma_f32_16x16x32_bf16 v[28:31], v[156:159], v[208:211], v[28:31]
  ds_read_b128 v[44:47], v16 offset:0
  ds_read_b128 v[48:51], v17 offset:0
  v_mfma_f32_16x16x32_bf16 v[32:35], v[156:159], v[192:195], v[32:35]
  ds_read_b128 v[52:55], v16 offset:512
  v_mfma_f32_16x16x32_bf16 v[36:39], v[156:159], v[184:187], v[36:39]
  ds_read_b128 v[56:59], v17 offset:512
  v_mfma_f32_16x16x32_bf16 v[28:31], v[164:167], v[200:203], v[28:31]
  ds_read_b128 v[60:63], v16 offset:1024
  ds_read_b128 v[64:67], v17 offset:1024
  v_mfma_f32_16x16x32_bf16 v[32:35], v[164:167], v[184:187], v[32:35]
  v_add_u32 v16, 64, v16
  v_mfma_f32_16x16x32_bf16 v[20:23], v[132:135], v[152:155], v[20:23]
  v_add_u32 v17, -64, v17
  v_mfma_f32_16x16x32_bf16 v[28:31], v[172:175], v[192:195], v[28:31]
  ds_read_b128 v[68:71], v8 offset:0
  ds_read_b128 v[72:75], v9 offset:0
  v_mfma_f32_16x16x32_bf16 v[32:35], v[172:175], v[176:179], v[32:35]
  ds_read_b128 v[76:79], v8 offset:512
  v_mfma_f32_16x16x32_bf16 v[36:39], v[164:167], v[176:179], v[36:39]
  ds_read_b128 v[80:83], v9 offset:512
  v_mfma_f32_16x16x32_bf16 v[28:31], v[180:183], v[184:187], v[28:31]
  ds_read_b128 v[84:87], v8 offset:1024
  ds_read_b128 v[88:91], v9 offset:1024
  v_mfma_f32_16x16x32_bf16 v[20:23], v[140:143], v[144:147], v[20:23]
  ds_read_b128 v[92:95], v8 offset:1536
  v_mfma_f32_16x16x32_bf16 v[32:35], v[180:183], v[168:171], v[32:35]
  ds_read_b128 v[96:99], v9 offset:1536
  v_mfma_f32_16x16x32_bf16 v[28:31], v[188:191], v[176:179], v[28:31]
  ds_read_b128 v[100:103], v8 offset:2048
  ds_read_b128 v[104:107], v9 offset:2048
  v_mfma_f32_16x16x32_bf16 v[36:39], v[172:175], v[168:171], v[36:39]
  ds_read_b128 v[108:111], v8 offset:2560
  v_mfma_f32_16x16x32_bf16 v[40:43], v[156:159], v[168:171], v[40:43]
  ds_read_b128 v[112:115], v9 offset:2560
  v_mfma_f32_16x16x32_bf16 v[28:31], v[196:199], v[168:171], v[28:31]
  ds_read_b128 v[116:119], v8 offset:3072
  ds_read_b128 v[120:123], v9 offset:3072
  v_mfma_f32_16x16x32_bf16 v[20:23], v[148:151], v[136:139], v[20:23]
  v_add_u32 v8, 64, v8
  v_mfma_f32_16x16x32_bf16 v[24:27], v[132:135], v[136:139], v[24:27]
  v_add_u32 v9, -64, v9
  v_mfma_f32_16x16x32_bf16 v[28:31], v[204:207], v[160:163], v[28:31]
  v_mfma_f32_16x16x32_bf16 v[32:35], v[188:191], v[160:163], v[32:35]
  v_mfma_f32_16x16x32_bf16 v[36:39], v[180:183], v[160:163], v[36:39]
  v_mfma_f32_16x16x32_bf16 v[40:43], v[164:167], v[160:163], v[40:43]
  s_sub_u32 s64, s64, 1
  s_cmp_lg_u32 s64, 0
  s_cbranch_scc1 Lcv_l3b
  s_waitcnt lgkmcnt(0)
  s_barrier
  v_cvt_pk_bf16_f32 v20, v20, v21
  v_cvt_pk_bf16_f32 v22, v22, v23
  ds_write_b32 v19, v20 offset:5120
  ds_write_b32 v19, v22 offset:5136
  v_cvt_pk_bf16_f32 v24, v24, v25
  v_cvt_pk_bf16_f32 v26, v26, v27
  ds_write_b32 v19, v24 offset:4096
  ds_write_b32 v19, v26 offset:4112
  v_cvt_pk_bf16_f32 v28, v28, v29
  v_cvt_pk_bf16_f32 v30, v30, v31
  ds_write_b32 v19, v28 offset:11264
  ds_write_b32 v19, v30 offset:11280
  v_cvt_pk_bf16_f32 v32, v32, v33
  v_cvt_pk_bf16_f32 v34, v34, v35
  ds_write_b32 v19, v32 offset:10240
  ds_write_b32 v19, v34 offset:10256
  v_cvt_pk_bf16_f32 v36, v36, v37
  v_cvt_pk_bf16_f32 v38, v38, v39
  ds_write_b32 v19, v36 offset:9728
  ds_write_b32 v19, v38 offset:9744
  v_cvt_pk_bf16_f32 v40, v40, v41
  v_cvt_pk_bf16_f32 v42, v42, v43
  ds_write_b32 v19, v40 offset:8704
  ds_write_b32 v19, v42 offset:8720
Lcv_bar2:
  s_waitcnt lgkmcnt(0)
  s_barrier
  ds_read_b128 v[32:35], v224 offset:0
  ds_read_b128 v[36:39], v224 offset:4096
  ds_read_b128 v[40:43], v224 offset:8192
  s_lshr_b32 s70, s3, 1
  s_xor_b32 s70, s70, s57
  s_cmp_eq_u32 s70, 0
  s_cselect_b32 s66, -1, 0
  s_cselect_b32 s67, 0, -1
  s_waitcnt lgkmcnt(2)
  v_lshlrev_b32 v48, 16, v32
  v_and_b32 v49, 0xffff0000, v32
  v_lshlrev_b32 v50, 16, v33
  v_and_b32 v51, 0xffff0000, v33
  v_lshlrev_b32 v52, 16, v34
  v_and_b32 v53, 0xffff0000, v34
  v_lshlrev_b32 v54, 16, v35
  v_and_b32 v55, 0xffff0000, v35
  v_pk_add_f32 v[48:49], v[48:49], v[226:227]
  v_pk_add_f32 v[50:51], v[50:51], v[228:229]
  v_pk_add_f32 v[52:53], v[52:53], v[230:231]
  v_pk_add_f32 v[54:55], v[54:55], v[232:233]
  v_cvt_pk_bf16_f32 v32, v48, v49
  v_cvt_pk_bf16_f32 v33, v50, v51
  v_cvt_pk_bf16_f32 v34, v52, v53
  v_cvt_pk_bf16_f32 v35, v54, v55
  s_lshl_b32 s70, s58, 12
  s_add_u32 s70, s70, 4194304
  buffer_store_dwordx4 v[32:35], v224, s[12:15], s70 offen sc1
  s_waitcnt lgkmcnt(1)
  v_lshlrev_b32 v56, 16, v36
  v_and_b32 v57, 0xffff0000, v36
  v_lshlrev_b32 v58, 16, v37
  v_and_b32 v59, 0xffff0000, v37
  v_lshlrev_b32 v60, 16, v38
  v_and_b32 v61, 0xffff0000, v38
  v_lshlrev_b32 v62, 16, v39
  v_and_b32 v63, 0xffff0000, v39
  v_pk_add_f32 v[56:57], v[56:57], v[234:235]
  v_pk_add_f32 v[58:59], v[58:59], v[236:237]
  v_pk_add_f32 v[60:61], v[60:61], v[238:239]
  v_pk_add_f32 v[62:63], v[62:63], v[240:241]
  v_cvt_pk_bf16_f32 v36, v56, v57
  v_cvt_pk_bf16_f32 v37, v58, v59
  v_cvt_pk_bf16_f32 v38, v60, v61
  v_cvt_pk_bf16_f32 v39, v62, v63
  s_lshl_b32 s70, s59, 12
  s_add_u32 s70, s70, 4194304
  buffer_store_dwordx4 v[36:39], v224, s[12:15], s70 offen sc1
  s_waitcnt lgkmcnt(0)
  v_lshlrev_b32 v64, 16, v40
  v_and_b32 v65, 0xffff0000, v40
  v_lshlrev_b32 v66, 16, v41
  v_and_b32 v67, 0xffff0000, v41
  v_lshlrev_b32 v68, 16, v42
  v_and_b32 v69, 0xffff0000, v42
  v_lshlrev_b32 v70, 16, v43
  v_and_b32 v71, 0xffff0000, v43
  v_pk_add_f32 v[64:65], v[64:65], v[242:243]
  v_pk_add_f32 v[66:67], v[66:67], v[244:245]
  v_pk_add_f32 v[68:69], v[68:69], v[246:247]
  v_pk_add_f32 v[70:71], v[70:71], v[248:249]
  v_cvt_pk_bf16_f32 v40, v64, v65
  v_cvt_pk_bf16_f32 v41, v66, v67
  v_cvt_pk_bf16_f32 v42, v68, v69
  v_cvt_pk_bf16_f32 v43, v70, v71
  s_lshl_b32 s70, s61, 12
  s_add_u32 s70, s70, 4194304
  s_mov_b64 exec, s[66:67]
  buffer_store_dwordx4 v[40:43], v224, s[12:15], s70 offen sc1
  s_mov_b64 exec, -1
  s_waitcnt vmcnt(0)
  s_barrier
  s_cmp_eq_u32 s3, 1
  s_cbranch_scc1 Lcv_ep
  s_cmp_lg_u32 s3, 0
  s_cbranch_scc1 Lend
  s_lshl_b32 s70, s54, 7
  s_add_u32 s70, s70, 65536
  v_mov_b32 v4, s52
  v_mov_b32 v5, 0
  s_mov_b64 exec, 1
  buffer_store_dword v4, v5, s[12:15], s70 offen sc1
  s_mov_b64 exec, -1
  s_endpgm
Lcv_ep:
  s_cmp_lg_u32 s54, 0
  s_cbranch_scc1 Lend
  v_lshrrev_b32 v8, 3, v0
  v_mul_u32_u24 v8, 12288, v8
  v_and_b32 v4, 7, v0
  v_lshl_add_u32 v8, v4, 9, v8
  s_mov_b32 s72, 16781312
  s_mov_b32 s73, 16879616
  s_mov_b32 s74, 16977920
  s_mov_b32 s75, 17076224
  buffer_load_dword v4, v8, s[12:15], s72 offen sc1
  buffer_load_dword v5, v8, s[12:15], s73 offen sc1
  buffer_load_dword v6, v8, s[12:15], s74 offen sc1
  buffer_load_dword v7, v8, s[12:15], s75 offen sc1
  s_waitcnt vmcnt(0)
  v_cmp_ne_u32 s[66:67], s52, v7
  v_cmp_ne_u32 s[64:65], s52, v6
  v_cmp_ne_u32 s[62:63], s52, v5
  v_cmp_ne_u32 vcc, s52, v4
  s_nop 0
  s_or_b64 vcc, vcc, s[62:63]
  s_or_b64 vcc, vcc, s[64:65]
  s_or_b64 vcc, vcc, s[66:67]
  s_cmp_eq_u64 vcc, 0
  s_cbranch_scc1 Lok_26
  s_mov_b32 s60, 20000
Lspin_25:
  s_sleep 8
  buffer_load_dword v4, v8, s[12:15], s72 offen sc1
  buffer_load_dword v5, v8, s[12:15], s73 offen sc1
  buffer_load_dword v6, v8, s[12:15], s74 offen sc1
  buffer_load_dword v7, v8, s[12:15], s75 offen sc1
  s_waitcnt vmcnt(0)
  v_cmp_ne_u32 s[66:67], s52, v7
  v_cmp_ne_u32 s[64:65], s52, v6
  v_cmp_ne_u32 s[62:63], s52, v5
  v_cmp_ne_u32 vcc, s52, v4
  s_nop 0
  s_or_b64 vcc, vcc, s[62:63]
  s_or_b64 vcc, vcc, s[64:65]
  s_or_b64 vcc, vcc, s[66:67]
  s_cmp_eq_u64 vcc, 0
  s_cbranch_scc1 Lok_26
  s_sub_u32 s60, s60, 1
  s_cmp_lg_u32 s60, 0
  s_cbranch_scc1 Lspin_25
Lok_26:
  v_mul_u32_u24 v8, 128, v0
  s_mov_b32 s72, 65536
  s_mov_b32 s73, 73728
  s_mov_b32 s74, 81920
  s_mov_b32 s75, 90112
  buffer_load_dword v4, v8, s[12:15], s72 offen sc1
  buffer_load_dword v5, v8, s[12:15], s73 offen sc1
  buffer_load_dword v6, v8, s[12:15], s74 offen sc1
  buffer_load_dword v7, v8, s[12:15], s75 offen sc1
  s_waitcnt vmcnt(0)
  v_cmp_ne_u32 s[66:67], s52, v7
  v_cmp_ne_u32 s[64:65], s52, v6
  v_cmp_ne_u32 s[62:63], s52, v5
  v_cmp_ne_u32 vcc, s52, v4
  s_nop 0
  s_or_b64 vcc, vcc, s[62:63]
  s_or_b64 vcc, vcc, s[64:65]
  s_or_b64 vcc, vcc, s[66:67]
  s_cmp_eq_u64 vcc, 0
  s_cbranch_scc1 Lok_28
  s_mov_b32 s60, 20000
Lspin_27:
  s_sleep 8
  buffer_load_dword v4, v8, s[12:15], s72 offen sc1
  buffer_load_dword v5, v8, s[12:15], s73 offen sc1
  buffer_load_dword v6, v8, s[12:15], s74 offen sc1
  buffer_load_dword v7, v8, s[12:15], s75 offen sc1
  s_waitcnt vmcnt(0)
  v_cmp_ne_u32 s[66:67], s52, v7
  v_cmp_ne_u32 s[64:65], s52, v6
  v_cmp_ne_u32 s[62:63], s52, v5
  v_cmp_ne_u32 vcc, s52, v4
  s_nop 0
  s_or_b64 vcc, vcc, s[62:63]
  s_or_b64 vcc, vcc, s[64:65]
  s_or_b64 vcc, vcc, s[66:67]
  s_cmp_eq_u64 vcc, 0
  s_cbranch_scc1 Lok_28
  s_sub_u32 s60, s60, 1
  s_cmp_lg_u32 s60, 0
  s_cbranch_scc1 Lspin_27
Lok_28:
  v_mov_b32 v4, s52
  v_mov_b32 v5, 0
  s_mov_b64 exec, 1
  buffer_store_dword v4, v5, s[12:15], 0 offen sc1
  s_mov_b64 exec, -1
  s_endpgm
Lend:
  s_endpgm
.section .rodata,"a"
.p2align 6
.amdhsa_kernel parallel_sum__ssm_conv_s4__dense_activation_mish__prompt_kernel
  .amdhsa_next_free_vgpr 256
  .amdhsa_next_free_sgpr 102
  .amdhsa_accum_offset 256
  .amdhsa_group_segment_fixed_size 0
  .amdhsa_kernarg_size 128
  .amdhsa_user_sgpr_count 2
  .amdhsa_user_sgpr_kernarg_segment_ptr 1
  .amdhsa_system_sgpr_workgroup_id_x 1
.end_amdhsa_kernel
```
